```python
import torch

def _softmax(x, axis=-1):
    return torch.softmax(x, dim=axis)
def _gelu(x):
    return torch.nn.functional.gelu(x, approximate="tanh")
def _silu(x):
    return torch.nn.functional.silu(x)
def _sigmoid(x):
    return torch.sigmoid(x)
def _layernorm(x, axis=-1, eps=1e-5):
    m = x.mean(dim=axis, keepdim=True)
    v = x.var(dim=axis, keepdim=True, unbiased=False)
    return (x - m) / torch.sqrt(v + eps)
def _scatter_add(tgt, idx, src, axis=0):
    return tgt.clone().index_add_(axis, idx, src)
def _segment_sum(src, seg, n):
    out = torch.zeros((n,) + src.shape[1:], dtype=src.dtype)
    return out.index_add_(0, seg, src)
def _pad(x, pw):
    flat = tuple(v for pair in reversed(pw) for v in pair)
    return torch.nn.functional.pad(x, flat)

kernel_name = 'recurrent_scan__ssm_conv_s4d__dense_activation_mish__prompt'

def setup_inputs():

    _w = (lambda a: (lambda t: t.to(torch.bfloat16) if t.is_floating_point() else t)(torch.as_tensor(a)))
    def _A_setup():
        Bsz, L, D, N = 1, 2048, 512, 128
        return {
            "u": _w((lambda *s: torch.randn(*s, dtype=torch.bfloat16) * 0.05)(Bsz, L, D)),
            "log_A_real": _w((lambda *s: torch.randn(*s, dtype=torch.bfloat16) * 3.2)(D, N) * 0.5),
            "A_imag": _w((lambda *s: torch.randn(*s, dtype=torch.bfloat16) * 0.2)(D, N) * 3.14),
            "C_real": _w((lambda *s: torch.randn(*s, dtype=torch.bfloat16) * 0.8)(D, N) / N ** 0.5),
            "C_imag": _w((lambda *s: torch.randn(*s, dtype=torch.bfloat16) * 0.8)(D, N) / N ** 0.5),
            "log_dt": _w((lambda *s: torch.randn(*s, dtype=torch.bfloat16) * 0.2)(D) * 0.5 - 4.0),
            "D_skip": _w((lambda *s: torch.randn(*s, dtype=torch.bfloat16) * 0.2)(D)),
        }
    _A_in = _A_setup()

    def _B_setup():
        B, S, D, F = 1, 2048, 512, 1792
        return {
            "x": _w((lambda *s: torch.randn(*s, dtype=torch.bfloat16) * 0.05)(B, S, D)),
            "w1": _w((lambda *s: torch.randn(*s, dtype=torch.bfloat16) * 0.8)(D, F) * (D ** -0.5)),
            "b1": _w((lambda *s: torch.randn(*s, dtype=torch.bfloat16) * 0.4)(F)),
            "w2": _w((lambda *s: torch.randn(*s, dtype=torch.bfloat16) * 0.1)(F, D) * (F ** -0.5)),
        }
    _B_in = _B_setup()

    return {
        "A_u": _A_in["u"],
        "A_log_A_real": _A_in["log_A_real"],
        "A_A_imag": _A_in["A_imag"],
        "A_C_real": _A_in["C_real"],
        "A_C_imag": _A_in["C_imag"],
        "A_log_dt": _A_in["log_dt"],
        "A_D_skip": _A_in["D_skip"],
        "B_x": _B_in["x"],
        "B_w1": _B_in["w1"],
        "B_b1": _B_in["b1"],
        "B_w2": _B_in["w2"],
    }

def reference(A_u, A_log_A_real, A_A_imag, A_C_real, A_C_imag, A_log_dt, A_D_skip, B_x, B_w1, B_b1, B_w2):
    def _A_ref(u, log_A_real, A_imag, C_real, C_imag, log_dt, D_skip):
        L = u.shape[1]
        dt = torch.exp(log_dt)
        A = -torch.exp(log_A_real) + 1j * A_imag
        C = (C_real + 1j * C_imag) * dt[:, None]
        pos = (lambda x, dt: x.to(dt))(torch.arange(L), log_dt.dtype)
        P = torch.exp((A * dt[:, None])[:, :, None] * pos[None, None, :])
        K = 2.0 * torch.einsum("dn,dnl->dl", C, P).real
        L2 = 2 * L
        u_t = (lambda x, *d: x.permute(*d))(u, 0, 2, 1)
        Kf = (lambda x, *a, **k: torch.fft.rfft(x.float(), *a, **k))(K, L2)
        Uf = (lambda x, *a, **k: torch.fft.rfft(x.float(), *a, **k))(u_t, L2)
        y = (lambda x, *a, **k: torch.fft.irfft(x, *a, **k).to(torch.bfloat16))(Uf * Kf[None, :, :], L2)[:, :, :L]
        y = (lambda x, *d: x.permute(*d))(y, 0, 2, 1)
        return y + u * D_skip[None, None, :]

    def _B_ref(x, w1, b1, w2):
        h = torch.einsum("bsd,df->bsf", x, w1) + b1
        sp = torch.log1p(torch.exp(-torch.abs(h))) + torch.where(h > 0, h, torch.zeros_like(h))
        act = h * torch.tanh(sp)
        return torch.einsum("bsf,fd->bsd", act, w2)

    x = A_u
    xn = _layernorm(x, axis=-1)
    s = _A_ref(xn, A_log_A_real, A_A_imag, A_C_real, A_C_imag, A_log_dt, A_D_skip)
    g = _silu(_B_ref(xn, B_w1, B_b1, B_w2))
    return x + s * g
```

```asm
; @launch grid=(256,1,1) block=(768,1,1) lds=163840
.amdgcn_target "amdgcn-amd-amdhsa--gfx950"
.text
.globl recurrent_scan__ssm_conv_s4d__dense_activation_mish__prompt_kernel
.p2align 8
.type recurrent_scan__ssm_conv_s4d__dense_activation_mish__prompt_kernel,@function
recurrent_scan__ssm_conv_s4d__dense_activation_mish__prompt_kernel:
    s_load_dwordx16 s[8:23], s[0:1], 0
    s_load_dwordx8 s[24:31], s[0:1], 64
    s_load_dwordx4 s[32:35], s[0:1], 96
    s_getpc_b64 s[60:61]
L_pc:
    s_cmp_ge_u32 s2, 256
    s_cbranch_scc1 L_end
    s_and_b32 s4, s2, 0xf8
    v_add_lshl_u32 v2, v0, s4, 7
    v_min_u32 v2, L_code_end-L_pc-4, v2
    v_cmp_gt_u32 vcc, 8, v0
    v_lshrrev_b32 v1, 6, v0
    v_and_b32 v0, 63, v0
    s_and_saveexec_b64 s[4:5], vcc
    s_cbranch_execz L_nopf
    global_load_dword v57, v2, s[60:61]
    s_cmp_lg_u32 s2, 1
    s_cbranch_scc1 L_nopf
    s_memrealtime s[64:65]
    v_mov_b32 v12, 0
    s_mov_b64 exec, 1
    s_waitcnt lgkmcnt(0)
    s_or_b32 s64, s64, 1
    v_mov_b32 v10, s64
    global_store_dword v12, v10, s[32:33] sc1
L_nopf:
    s_mov_b64 exec, -1
    v_readfirstlane_b32 s3, v1
    s_and_b32 s36, s2, 7
    s_lshr_b32 s37, s2, 3
    s_lshl_b32 s38, s36, 1
    s_and_b32 s39, s37, 1
    s_add_u32 s38, s38, s39
    s_lshr_b32 s39, s37, 1
    s_min_u32 s39, s39, 13
    s_and_b32 s4, s37, 3
    s_lshr_b32 s41, s37, 2
    s_lshl_b32 s40, s36, 2
    s_add_u32 s40, s40, s4
    s_xor_b32 s41, s41, 4
    s_lshl_b32 s43, s36, 5
    s_add_u32 s43, s43, s37
    s_and_b32 s42, s3, 3
    s_mov_b32 s7, 0
    s_mov_b32 s6, 0
    s_and_b32 s5, s37, 1
    s_mul_i32 s5, s5, 0
    s_add_u32 s5, s5, s39
    s_add_u32 s5, s5, s36
    s_and_b32 s5, s5, 7
    v_lshlrev_b32 v1, 4, v0
    s_lshr_b32 s66, s42, 1
    s_and_b32 s67, s42, 1
    s_cmp_ge_u32 s3, 8
    s_cbranch_scc1 L_D
    s_cmp_lt_u32 s3, 4
    s_cbranch_scc1 L_Me
    s_lshl_b32 s68, s36, 6
    s_lshl_b32 s65, s37, 1
    s_add_u32 s68, s68, s65
    s_add_u32 s69, s68, s66
    s_lshl_b32 s65, s69, 1
    v_mov_b32 v4, s65
    s_lshl_b32 s65, s69, 8
    s_lshl_b32 s64, s67, 7
    s_add_u32 s65, s65, s64
    v_lshl_add_u32 v3, v0, 1, s65
    s_lshl_b32 s65, s39, 8
    s_lshl_b32 s64, s42, 6
    s_add_u32 s65, s65, s64
    v_and_b32 v6, 31, v0
    v_lshl_add_u32 v5, v6, 1, s65
    s_waitcnt lgkmcnt(0)
    global_load_ushort v152, v4, s[18:19]
    global_load_ushort v153, v3, s[10:11]
    global_load_ushort v154, v3, s[12:13]
    global_load_ushort v155, v3, s[14:15]
    global_load_ushort v156, v3, s[16:17]
    global_load_ushort v166, v4, s[20:21]
    global_load_ushort v167, v5, s[26:27]
    s_branch L_L
L_Me:
    s_lshl_b32 s64, s43, 13
    s_lshl_b32 s65, s42, 11
    s_add_u32 s64, s64, s65
    v_lshrrev_b32 v2, 5, v0
    v_lshlrev_b32 v2, 9, v2
    v_add3_u32 v2, v2, v1, s64
    s_waitcnt lgkmcnt(0)
    global_load_dwordx4 v[128:131], v2, s[8:9]
    global_load_dwordx4 v[132:135], v2, s[8:9] offset:512
    s_branch L_M
L_D:
    v_lshrrev_b32 v1, 3, v0
    v_and_b32 v2, 7, v0
    v_lshrrev_b32 v3, 4, v0
    v_xor_b32 v4, v2, v3
    v_lshlrev_b32 v4, 4, v4
    v_lshl_add_u32 v4, v1, 10, v4
    v_xor_b32 v5, 64, v4
    v_and_b32 v6, 15, v0
    v_lshlrev_b32 v7, 2, v3
    v_xor_b32 v6, v6, v7
    v_lshlrev_b32 v6, 4, v6
    v_mul_u32_u24 v7, 3584, v3
    v_add_u32 v6, v6, v7
    s_mov_b32 s64, s5
    s_lshl_b32 s74, s38, 17
    s_lshl_b32 s65, s42, 15
    s_add_u32 s74, s74, s65
    s_mul_i32 s75, s42, 57344
    s_lshl_b32 s65, s39, 8
    s_add_u32 s75, s75, s65
    s_lshl_b32 s68, s42, 12
    s_add_u32 s68, s68, 32768
    s_mov_b32 s69, 0
    s_mov_b32 s50, 0x00200000
    s_mov_b32 s51, 0x20000
    s_mov_b32 s54, 0x001c0000
    s_mov_b32 s55, 0x20000
    s_mov_b32 s58, 0x001c0000
    s_mov_b32 s59, 0x20000
    s_waitcnt lgkmcnt(0)
    s_mov_b32 s48, s8
    s_mov_b32 s49, s9
    s_mov_b32 s52, s24
    s_mov_b32 s53, s25
    s_mov_b32 s56, s28
    s_mov_b32 s57, s29
    s_cmp_ge_u32 s37, 28
    s_cbranch_scc1 L_Dsetup
    s_add_u32 s72, s69, 1
    s_and_b32 s72, s72, 3
    s_lshl_b32 s72, s72, 15
    s_lshl_b32 s70, s64, 7
    s_add_u32 s70, s70, s74
    s_mul_i32 s71, s64, 229376
    s_add_u32 s71, s71, s75
    s_add_u32 m0, s72, s68
    s_nop 0
    buffer_load_dwordx4 v4, s[48:51], s70 offen offset:0 lds
    s_add_u32 s70, s70, 7168
    buffer_load_dwordx4 v5, s[48:51], s70 offen offset:1024 lds
    s_add_u32 s70, s70, 7168
    buffer_load_dwordx4 v4, s[48:51], s70 offen offset:2048 lds
    s_add_u32 s70, s70, 7168
    buffer_load_dwordx4 v5, s[48:51], s70 offen offset:3072 lds
    s_add_u32 m0, m0, 0x4000
    s_add_u32 s64, s64, 1
    buffer_load_dwordx4 v6, s[52:55], s71 offen offset:0 lds
    s_add_u32 s71, s71, 13312
    buffer_load_dwordx4 v6, s[52:55], s71 offen offset:1024 lds
    s_add_u32 s71, s71, 13312
    buffer_load_dwordx4 v6, s[52:55], s71 offen offset:2048 lds
    s_add_u32 s71, s71, 13312
    buffer_load_dwordx4 v6, s[52:55], s71 offen offset:3072 lds
    s_and_b32 s64, s64, 7
    s_add_u32 s69, s69, 1
L_Dsetup:
    v_and_b32 v8, 1, v3
    v_lshlrev_b32 v7, 2, v8
    v_xor_b32 v7, v7, v2
    v_lshlrev_b32 v7, 4, v7
    v_lshl_add_u32 v7, v1, 10, v7
    s_mul_i32 s76, s66, 896
    s_lshl_b32 s76, s76, 10
    s_lshl_b32 s65, s41, 7
    s_add_u32 s76, s76, s65
    s_lshl_b32 s77, s42, 13
    s_add_u32 s77, s77, 32768
    v_and_b32 v9, 3, v0
    v_lshlrev_b32 v2, 2, v9
    s_lshl_b32 s70, s42, 2
    v_mov_b32 v3, s70
    v_lshl_add_u32 v1, v0, 4, s77
    v_add_u32 v14, 0x10000, v1
    v_mov_b32 v16, 9
    v_mov_b32 v17, 10
    v_mov_b32 v18, 11
    v_mov_b32 v19, 12
    v_mov_b32 v20, 13
    v_mov_b32 v21, 14
    v_mov_b32 v22, 15
    s_lshl_b32 s22, s42, 7
    s_lshl_b32 s23, s36, 9
    s_add_u32 s22, s22, s23
    s_add_u32 s22, s22, 4096
    s_add_u32 s20, s34, s22
    s_addc_u32 s21, s35, 0
    s_mov_b32 s44, s34
    s_mov_b32 s45, s35
    s_mov_b32 s46, 0x10000000
    s_mov_b32 s47, 0x20000
    s_lshr_b32 s65, s37, 4
    s_lshl_b32 s65, s65, 1
    s_and_b32 s70, s37, 1
    s_add_u32 s65, s65, s70
    s_lshl_b32 s65, s65, 3
    s_bfe_u32 s70, s37, 0x30001
    s_add_u32 s65, s65, s70
    s_lshl_b32 s70, s36, 5
    s_add_u32 s65, s65, s70
    s_lshl_b32 s65, s65, 7
    s_mul_i32 s73, s42, 526336
    s_add_u32 s73, s73, s65
    s_add_u32 s73, s73, 1048576
    v_lshrrev_b32 v164, 3, v0
    v_mul_u32_u24 v164, 32896, v164
    v_and_b32 v165, 7, v0
    v_lshl_add_u32 v164, v165, 4, v164
    s_lshl_b32 s65, s42, 11
    v_lshl_add_u32 v166, v0, 4, s65
    v_lshlrev_b32 v165, 1, v166
    v_add_u32 v165, 131072, v165
    v_lshl_add_u32 v167, v9, 2, s22
    s_mov_b32 s23, 0
    s_cmp_ge_u32 s37, 28
    s_cbranch_scc1 L_Dln2
    s_lshl_b32 s70, s38, 2
    s_add_u32 s70, s70, s42
    s_mul_i32 s70, s70, 112
    s_lshl_b32 s65, s39, 3
    s_add_u32 s70, s70, s65
    s_lshl_b32 s70, s70, 10
    s_add_u32 s70, s70, 5767168
    v_lshlrev_b32 v11, 7, v0
L_Dloop:
    s_add_u32 s72, s69, 1
    s_and_b32 s72, s72, 3
    s_lshl_b32 s72, s72, 15
    s_lshl_b32 s70, s64, 7
    s_add_u32 s70, s70, s74
    s_mul_i32 s71, s64, 229376
    s_add_u32 s71, s71, s75
    s_add_u32 m0, s72, s68
    s_nop 0
    buffer_load_dwordx4 v4, s[48:51], s70 offen offset:0 lds
    s_add_u32 s70, s70, 7168
    buffer_load_dwordx4 v5, s[48:51], s70 offen offset:1024 lds
    s_add_u32 s70, s70, 7168
    buffer_load_dwordx4 v4, s[48:51], s70 offen offset:2048 lds
    s_add_u32 s70, s70, 7168
    buffer_load_dwordx4 v5, s[48:51], s70 offen offset:3072 lds
    s_add_u32 m0, m0, 0x4000
    s_add_u32 s64, s64, 1
    buffer_load_dwordx4 v6, s[52:55], s71 offen offset:0 lds
    s_add_u32 s71, s71, 13312
    buffer_load_dwordx4 v6, s[52:55], s71 offen offset:1024 lds
    s_add_u32 s71, s71, 13312
    buffer_load_dwordx4 v6, s[52:55], s71 offen offset:2048 lds
    s_add_u32 s71, s71, 13312
    buffer_load_dwordx4 v6, s[52:55], s71 offen offset:3072 lds
    s_and_b32 s64, s64, 7
    s_add_u32 s69, s69, 1
    s_waitcnt vmcnt(8)
    s_barrier
    s_cmp_lt_u32 s69, 7
    s_cbranch_scc1 L_Dloop
    s_load_dword s63, s[32:33], 0
    s_add_u32 s72, s69, 1
    s_and_b32 s72, s72, 3
    s_lshl_b32 s72, s72, 15
    s_lshl_b32 s70, s64, 7
    s_add_u32 s70, s70, s74
    s_mul_i32 s71, s64, 229376
    s_add_u32 s71, s71, s75
    s_add_u32 m0, s72, s68
    s_nop 0
    buffer_load_dwordx4 v4, s[48:51], s70 offen offset:0 lds
    s_add_u32 s70, s70, 7168
    buffer_load_dwordx4 v5, s[48:51], s70 offen offset:1024 lds
    s_add_u32 s70, s70, 7168
    buffer_load_dwordx4 v4, s[48:51], s70 offen offset:2048 lds
    s_add_u32 s70, s70, 7168
    buffer_load_dwordx4 v5, s[48:51], s70 offen offset:3072 lds
    s_add_u32 m0, m0, 0x4000
    s_add_u32 s64, s64, 1
    buffer_load_dwordx4 v6, s[52:55], s71 offen offset:0 lds
    s_add_u32 s71, s71, 13312
    buffer_load_dwordx4 v6, s[52:55], s71 offen offset:1024 lds
    s_add_u32 s71, s71, 13312
    buffer_load_dwordx4 v6, s[52:55], s71 offen offset:2048 lds
    s_add_u32 s71, s71, 13312
    buffer_load_dwordx4 v6, s[52:55], s71 offen offset:3072 lds
    s_and_b32 s64, s64, 7
    s_add_u32 s69, s69, 1
    s_waitcnt vmcnt(8)
    s_barrier
    s_mov_b32 s48, s32
    s_mov_b32 s49, s33
    s_mov_b32 s50, 0x00000100
    s_mov_b32 s51, 0x20000
    s_waitcnt lgkmcnt(0)
    s_cmp_lg_u32 s63, 0
    s_cbranch_scc1 L_tf1
    v_mov_b32 v10, 0
    s_mov_b64 exec, 1
    s_mov_b32 s79, 100000
L_poll2:
    buffer_load_dword v11, v10, s[48:51], 0 offen sc1
    s_waitcnt vmcnt(0)
    v_cmp_eq_u32 vcc, 0, v11
    s_sub_u32 s79, s79, 1
    s_cbranch_scc1 L_polled2
    s_cmp_eq_u64 vcc, 0
    s_cbranch_scc1 L_polled2
    s_sleep 8
    s_branch L_poll2
L_polled2:
    s_mov_b64 exec, -1
    v_readfirstlane_b32 s63, v11
    s_nop 1
L_tf1:
    s_load_dwordx4 s[16:19], s[20:21], 0
    s_mul_i32 s70, s67, 0x00020000
    s_add_u32 s70, s70, s76
    s_add_u32 s70, s70, 0
    s_add_u32 m0, s77, 32768
    s_nop 0
    buffer_load_dwordx4 v7, s[56:59], s70 offen offset:0 lds
    s_add_u32 s70, s70, 7168
    buffer_load_dwordx4 v7, s[56:59], s70 offen offset:1024 lds
    s_add_u32 s70, s70, 7168
    buffer_load_dwordx4 v7, s[56:59], s70 offen offset:2048 lds
    s_add_u32 s70, s70, 7168
    buffer_load_dwordx4 v7, s[56:59], s70 offen offset:3072 lds
    s_add_u32 s70, s70, 44032
    s_add_u32 m0, m0, 0x1000
    s_nop 0
    buffer_load_dwordx4 v7, s[56:59], s70 offen offset:0 lds
    s_add_u32 s70, s70, 7168
    buffer_load_dwordx4 v7, s[56:59], s70 offen offset:1024 lds
    s_add_u32 s70, s70, 7168
    buffer_load_dwordx4 v7, s[56:59], s70 offen offset:2048 lds
    s_add_u32 s70, s70, 7168
    buffer_load_dwordx4 v7, s[56:59], s70 offen offset:3072 lds
    s_waitcnt vmcnt(8)
    s_barrier
    s_waitcnt lgkmcnt(0)
    s_mov_b32 s62, 0
    s_xor_b32 s16, s16, s63
    s_or_b32 s62, s62, s16
    s_xor_b32 s17, s17, s63
    s_or_b32 s62, s62, s17
    s_xor_b32 s18, s18, s63
    s_or_b32 s62, s62, s18
    s_xor_b32 s19, s19, s63
    s_or_b32 s62, s62, s19
    s_cbranch_scc0 L_xfd
    s_mov_b64 exec, 15
    s_mov_b32 s79, 100000
L_poll3:
    buffer_load_dword v15, v167, s[44:47], 0 offen sc1
    s_waitcnt vmcnt(0)
    v_cmp_ne_u32 vcc, s63, v15
    s_sub_u32 s79, s79, 1
    s_cbranch_scc1 L_polled3
    s_cmp_eq_u64 vcc, 0
    s_cbranch_scc1 L_polled3
    s_sleep 12
    s_branch L_poll3
L_polled3:
    s_mov_b64 exec, -1
L_xfd:
    s_add_u32 s65, s73, 263168
    buffer_load_dwordx4 v[24:27], v164, s[44:47], s73 offen sc1
    buffer_load_dwordx4 v[28:31], v164, s[44:47], s65 offen sc1
    buffer_load_dwordx4 v[32:35], v165, s[44:47], 0 offen offset:0 sc1
    buffer_load_dwordx4 v[36:39], v165, s[44:47], 0 offen offset:16 sc1
    buffer_load_dwordx4 v[40:43], v165, s[44:47], 0 offen offset:2048 sc1
    buffer_load_dwordx4 v[44:47], v165, s[44:47], 0 offen offset:2064 sc1
    s_mul_i32 s70, s67, 0x00020000
    s_add_u32 s70, s70, s76
    s_add_u32 s70, s70, 262144
    s_add_u32 m0, s77, 65536
    s_nop 0
    buffer_load_dwordx4 v7, s[56:59], s70 offen offset:0 lds
    s_add_u32 s70, s70, 7168
    buffer_load_dwordx4 v7, s[56:59], s70 offen offset:1024 lds
    s_add_u32 s70, s70, 7168
    buffer_load_dwordx4 v7, s[56:59], s70 offen offset:2048 lds
    s_add_u32 s70, s70, 7168
    buffer_load_dwordx4 v7, s[56:59], s70 offen offset:3072 lds
    s_add_u32 s70, s70, 44032
    s_add_u32 m0, m0, 0x1000
    s_nop 0
    buffer_load_dwordx4 v7, s[56:59], s70 offen offset:0 lds
    s_add_u32 s70, s70, 7168
    buffer_load_dwordx4 v7, s[56:59], s70 offen offset:1024 lds
    s_add_u32 s70, s70, 7168
    buffer_load_dwordx4 v7, s[56:59], s70 offen offset:2048 lds
    s_add_u32 s70, s70, 7168
    buffer_load_dwordx4 v7, s[56:59], s70 offen offset:3072 lds
    s_mov_b32 s62, 0xffff0000
    s_waitcnt vmcnt(8)
    s_setprio 1
    s_mov_b32 s79, 100000
L_tag:
    v_xor_b32 v48, s63, v33
    v_xor_b32 v35, s63, v35
    v_xor_b32 v49, s63, v37
    v_xor_b32 v39, s63, v39
    v_xor_b32 v50, s63, v41
    v_xor_b32 v43, s63, v43
    v_xor_b32 v51, s63, v45
    v_xor_b32 v47, s63, v47
    v_or3_b32 v48, v48, v49, v50
    v_or3_b32 v48, v48, v51, v35
    v_or3_b32 v48, v48, v39, v43
    v_or_b32 v48, v48, v47
    v_cmp_ne_u32 vcc, 0, v48
    s_sub_u32 s79, s79, 1
    s_cbranch_scc1 L_tagd
    s_cbranch_vccz L_tagd
    s_sleep 12
    buffer_load_dwordx4 v[32:35], v165, s[44:47], 0 offen offset:0 sc1
    buffer_load_dwordx4 v[36:39], v165, s[44:47], 0 offen offset:16 sc1
    buffer_load_dwordx4 v[40:43], v165, s[44:47], 0 offen offset:2048 sc1
    buffer_load_dwordx4 v[44:47], v165, s[44:47], 0 offen offset:2064 sc1
    s_waitcnt vmcnt(0)
    s_branch L_tag
L_tagd:
    s_mul_i32 s70, s67, 0x00020000
    s_add_u32 s70, s70, s76
    s_add_u32 s70, s70, 163840
    buffer_load_dwordx4 v[52:55], v7, s[56:59], s70 offen
    s_add_u32 s70, s70, 8192
    buffer_load_dwordx4 v[56:59], v7, s[56:59], s70 offen
    s_add_u32 s70, s70, 8192
    buffer_load_dwordx4 v[60:63], v7, s[56:59], s70 offen
    s_add_u32 s70, s70, 8192
    buffer_load_dwordx4 v[64:67], v7, s[56:59], s70 offen
    s_add_u32 s70, s70, 40960
    buffer_load_dwordx4 v[68:71], v7, s[56:59], s70 offen
    s_add_u32 s70, s70, 8192
    buffer_load_dwordx4 v[72:75], v7, s[56:59], s70 offen
    s_add_u32 s70, s70, 8192
    buffer_load_dwordx4 v[76:79], v7, s[56:59], s70 offen
    s_add_u32 s70, s70, 8192
    buffer_load_dwordx4 v[80:83], v7, s[56:59], s70 offen
    s_setprio 3
    v_lshlrev_b32 v33, 16, v32
    v_and_b32 v32, s62, v32
    v_lshlrev_b32 v35, 16, v34
    v_and_b32 v34, s62, v34
    v_lshlrev_b32 v37, 16, v36
    v_and_b32 v36, s62, v36
    v_lshlrev_b32 v39, 16, v38
    v_and_b32 v38, s62, v38
    v_rcp_f32 v32, v32
    v_rcp_f32 v34, v34
    v_rcp_f32 v36, v36
    v_rcp_f32 v38, v38
    v_lshlrev_b32 v48, 16, v24
    v_and_b32 v49, s62, v24
    v_sub_f32 v48, v48, v33
    v_sub_f32 v49, v49, v35
    v_cvt_pk_bf16_f32 v24, v48, v49
    v_lshlrev_b32 v48, 16, v24
    v_and_b32 v49, s62, v24
    v_mul_f32 v48, v48, v32
    v_mul_f32 v49, v49, v34
    v_cvt_pk_bf16_f32 v24, v48, v49
    v_lshlrev_b32 v48, 16, v25
    v_and_b32 v49, s62, v25
    v_sub_f32 v48, v48, v37
    v_sub_f32 v49, v49, v39
    v_cvt_pk_bf16_f32 v25, v48, v49
    v_lshlrev_b32 v48, 16, v25
    v_and_b32 v49, s62, v25
    v_mul_f32 v48, v48, v36
    v_mul_f32 v49, v49, v38
    v_cvt_pk_bf16_f32 v25, v48, v49
    v_lshlrev_b32 v48, 16, v26
    v_and_b32 v49, s62, v26
    v_sub_f32 v48, v48, v33
    v_sub_f32 v49, v49, v35
    v_cvt_pk_bf16_f32 v26, v48, v49
    v_lshlrev_b32 v48, 16, v26
    v_and_b32 v49, s62, v26
    v_mul_f32 v48, v48, v32
    v_mul_f32 v49, v49, v34
    v_cvt_pk_bf16_f32 v26, v48, v49
    v_lshlrev_b32 v48, 16, v27
    v_and_b32 v49, s62, v27
    v_sub_f32 v48, v48, v37
    v_sub_f32 v49, v49, v39
    v_cvt_pk_bf16_f32 v27, v48, v49
    v_lshlrev_b32 v48, 16, v27
    v_and_b32 v49, s62, v27
    v_mul_f32 v48, v48, v36
    v_mul_f32 v49, v49, v38
    v_cvt_pk_bf16_f32 v27, v48, v49
    s_setprio 0
    s_mul_i32 s70, s67, 0x00020000
    s_add_u32 s70, s70, s76
    s_add_u32 s70, s70, 425984
    s_waitcnt vmcnt(6)
    buffer_load_dwordx4 v[84:87], v7, s[56:59], s70 offen
    s_add_u32 s70, s70, 8192
    s_waitcnt vmcnt(6)
    buffer_load_dwordx4 v[88:91], v7, s[56:59], s70 offen
    s_add_u32 s70, s70, 8192
    s_waitcnt vmcnt(6)
    buffer_load_dwordx4 v[92:95], v7, s[56:59], s70 offen
    s_add_u32 s70, s70, 8192
    s_waitcnt vmcnt(6)
    buffer_load_dwordx4 v[96:99], v7, s[56:59], s70 offen
    s_add_u32 s70, s70, 40960
    s_waitcnt vmcnt(6)
    buffer_load_dwordx4 v[100:103], v7, s[56:59], s70 offen
    s_add_u32 s70, s70, 8192
    s_waitcnt vmcnt(6)
    buffer_load_dwordx4 v[104:107], v7, s[56:59], s70 offen
    s_add_u32 s70, s70, 8192
    s_waitcnt vmcnt(6)
    buffer_load_dwordx4 v[108:111], v7, s[56:59], s70 offen
    s_add_u32 s70, s70, 8192
    s_waitcnt vmcnt(6)
    buffer_load_dwordx4 v[112:115], v7, s[56:59], s70 offen
    s_setprio 3
    v_lshlrev_b32 v41, 16, v40
    v_and_b32 v40, s62, v40
    v_lshlrev_b32 v43, 16, v42
    v_and_b32 v42, s62, v42
    v_lshlrev_b32 v45, 16, v44
    v_and_b32 v44, s62, v44
    v_lshlrev_b32 v47, 16, v46
    v_and_b32 v46, s62, v46
    v_rcp_f32 v40, v40
    v_rcp_f32 v42, v42
    v_rcp_f32 v44, v44
    v_rcp_f32 v46, v46
    v_lshlrev_b32 v48, 16, v28
    v_and_b32 v49, s62, v28
    v_sub_f32 v48, v48, v41
    v_sub_f32 v49, v49, v43
    v_cvt_pk_bf16_f32 v28, v48, v49
    v_lshlrev_b32 v48, 16, v28
    v_and_b32 v49, s62, v28
    v_mul_f32 v48, v48, v40
    v_mul_f32 v49, v49, v42
    v_cvt_pk_bf16_f32 v28, v48, v49
    v_lshlrev_b32 v48, 16, v29
    v_and_b32 v49, s62, v29
    v_sub_f32 v48, v48, v45
    v_sub_f32 v49, v49, v47
    v_cvt_pk_bf16_f32 v29, v48, v49
    v_lshlrev_b32 v48, 16, v29
    v_and_b32 v49, s62, v29
    v_mul_f32 v48, v48, v44
    v_mul_f32 v49, v49, v46
    v_cvt_pk_bf16_f32 v29, v48, v49
    v_lshlrev_b32 v48, 16, v30
    v_and_b32 v49, s62, v30
    v_sub_f32 v48, v48, v41
    v_sub_f32 v49, v49, v43
    v_cvt_pk_bf16_f32 v30, v48, v49
    v_lshlrev_b32 v48, 16, v30
    v_and_b32 v49, s62, v30
    v_mul_f32 v48, v48, v40
    v_mul_f32 v49, v49, v42
    v_cvt_pk_bf16_f32 v30, v48, v49
    v_lshlrev_b32 v48, 16, v31
    v_and_b32 v49, s62, v31
    v_sub_f32 v48, v48, v45
    v_sub_f32 v49, v49, v47
    v_cvt_pk_bf16_f32 v31, v48, v49
    v_lshlrev_b32 v48, 16, v31
    v_and_b32 v49, s62, v31
    v_mul_f32 v48, v48, v44
    v_mul_f32 v49, v49, v46
    v_cvt_pk_bf16_f32 v31, v48, v49
    s_setprio 0
    ds_write_b128 v166, v[24:27] offset:17920
    ds_write_b128 v166, v[28:31] offset:18944
    s_mov_b64 exec, 1
    ds_write_b32 v3, v16 offset:31824
    s_mov_b64 exec, -1
    s_mov_b64 exec, 1
    ds_write_b32 v3, v17 offset:31744
    s_mov_b64 exec, -1
    s_mul_i32 s70, s67, 0x00020000
    s_add_u32 s70, s70, s76
    s_add_u32 s70, s70, 688128
    s_waitcnt vmcnt(6)
    buffer_load_dwordx4 v[116:119], v7, s[56:59], s70 offen
    s_add_u32 s70, s70, 8192
    s_waitcnt vmcnt(6)
    buffer_load_dwordx4 v[120:123], v7, s[56:59], s70 offen
    s_add_u32 s70, s70, 8192
    s_waitcnt vmcnt(6)
    buffer_load_dwordx4 v[124:127], v7, s[56:59], s70 offen
    s_add_u32 s70, s70, 8192
    s_waitcnt vmcnt(6)
    buffer_load_dwordx4 v[128:131], v7, s[56:59], s70 offen
    s_add_u32 s70, s70, 40960
    s_waitcnt vmcnt(6)
    buffer_load_dwordx4 v[132:135], v7, s[56:59], s70 offen
    s_add_u32 s70, s70, 8192
    s_waitcnt vmcnt(6)
    buffer_load_dwordx4 v[136:139], v7, s[56:59], s70 offen
    s_add_u32 s70, s70, 8192
    s_waitcnt vmcnt(6)
    buffer_load_dwordx4 v[140:143], v7, s[56:59], s70 offen
    s_add_u32 s70, s70, 8192
    s_waitcnt vmcnt(6)
    buffer_load_dwordx4 v[144:147], v7, s[56:59], s70 offen
    s_setprio 3
    s_mov_b32 s79, 400000
L_lw4:
    ds_read_b32 v10, v2 offset:31792
    s_waitcnt lgkmcnt(0)
    v_cmp_gt_u32 vcc, 2, v10
    s_sub_u32 s79, s79, 1
    s_cbranch_scc1 L_lwd4
    s_cbranch_vccz L_lwd4
    s_sleep 1
    s_branch L_lw4
L_lwd4:
    s_setprio 0
    s_mul_i32 s70, s67, 0x00020000
    s_add_u32 s70, s70, s76
    s_add_u32 s70, s70, 524288
    s_add_u32 m0, s77, 98304
    s_waitcnt vmcnt(6)
    buffer_load_dwordx4 v7, s[56:59], s70 offen offset:0 lds
    s_add_u32 s70, s70, 7168
    s_waitcnt vmcnt(6)
    buffer_load_dwordx4 v7, s[56:59], s70 offen offset:1024 lds
    s_add_u32 s70, s70, 7168
    s_waitcnt vmcnt(6)
    buffer_load_dwordx4 v7, s[56:59], s70 offen offset:2048 lds
    s_add_u32 s70, s70, 7168
    s_waitcnt vmcnt(6)
    buffer_load_dwordx4 v7, s[56:59], s70 offen offset:3072 lds
    s_add_u32 s70, s70, 44032
    s_add_u32 m0, m0, 0x1000
    s_waitcnt vmcnt(6)
    buffer_load_dwordx4 v7, s[56:59], s70 offen offset:0 lds
    s_add_u32 s70, s70, 7168
    s_waitcnt vmcnt(6)
    buffer_load_dwordx4 v7, s[56:59], s70 offen offset:1024 lds
    s_add_u32 s70, s70, 7168
    s_waitcnt vmcnt(6)
    buffer_load_dwordx4 v7, s[56:59], s70 offen offset:2048 lds
    s_add_u32 s70, s70, 7168
    s_waitcnt vmcnt(6)
    buffer_load_dwordx4 v7, s[56:59], s70 offen offset:3072 lds
    s_mul_i32 s70, s67, 0xfff48000
    s_add_u32 s70, s70, s76
    s_add_u32 s70, s70, 786432
    s_add_u32 m0, s77, 0
    s_waitcnt vmcnt(6)
    buffer_load_dwordx4 v7, s[56:59], s70 offen offset:0 lds
    s_add_u32 s70, s70, 7168
    s_waitcnt vmcnt(6)
    buffer_load_dwordx4 v7, s[56:59], s70 offen offset:1024 lds
    s_add_u32 s70, s70, 7168
    s_waitcnt vmcnt(6)
    buffer_load_dwordx4 v7, s[56:59], s70 offen offset:2048 lds
    s_add_u32 s70, s70, 7168
    s_waitcnt vmcnt(6)
    buffer_load_dwordx4 v7, s[56:59], s70 offen offset:3072 lds
    s_add_u32 s70, s70, 44032
    s_add_u32 m0, m0, 0x1000
    s_waitcnt vmcnt(6)
    buffer_load_dwordx4 v7, s[56:59], s70 offen offset:0 lds
    s_add_u32 s70, s70, 7168
    s_waitcnt vmcnt(6)
    buffer_load_dwordx4 v7, s[56:59], s70 offen offset:1024 lds
    s_add_u32 s70, s70, 7168
    s_waitcnt vmcnt(6)
    buffer_load_dwordx4 v7, s[56:59], s70 offen offset:2048 lds
    s_add_u32 s70, s70, 7168
    s_waitcnt vmcnt(6)
    buffer_load_dwordx4 v7, s[56:59], s70 offen offset:3072 lds
    s_waitcnt vmcnt(8)
    s_mov_b64 exec, 1
    ds_write_b32 v3, v18 offset:31744
    s_mov_b64 exec, -1
    s_waitcnt vmcnt(0)
    s_mov_b64 exec, 1
    ds_write_b32 v3, v19 offset:31744
    s_mov_b64 exec, -1
    s_waitcnt vmcnt(0)
L_Dtail:
    s_mov_b32 s52, s8
    s_mov_b32 s53, s9
    s_mov_b32 s54, 0x00200000
    s_mov_b32 s55, 0x20000
    s_lshl_b32 s70, s40, 16
    s_lshl_b32 s64, s42, 14
    s_add_u32 s70, s70, s64
    s_lshl_b32 s64, s41, 7
    s_add_u32 s70, s70, s64
    s_add_u32 s71, s70, 0x2000
    buffer_load_dwordx4 v[24:27], v4, s[52:55], s70 offen
    buffer_load_dwordx4 v[28:31], v5, s[52:55], s71 offen
    s_setprio 3
    s_mov_b32 s79, 400000
L_lw5:
    ds_read_b32 v10, v2 offset:31760
    s_waitcnt lgkmcnt(0)
    v_cmp_gt_u32 vcc, 9, v10
    s_sub_u32 s79, s79, 1
    s_cbranch_scc1 L_lwd5
    s_cbranch_vccz L_lwd5
    s_sleep 2
    s_branch L_lw5
L_lwd5:
    s_setprio 0
    ds_write_b128 v1, v[52:55] offset:32768
    ds_write_b128 v1, v[56:59] offset:33792
    ds_write_b128 v1, v[60:63] offset:34816
    ds_write_b128 v1, v[64:67] offset:35840
    ds_write_b128 v1, v[68:71] offset:36864
    ds_write_b128 v1, v[72:75] offset:37888
    ds_write_b128 v1, v[76:79] offset:38912
    ds_write_b128 v1, v[80:83] offset:39936
    s_mov_b64 exec, 1
    ds_write_b32 v3, v20 offset:31744
    s_mov_b64 exec, -1
    s_setprio 3
    s_mov_b32 s79, 400000
L_lw6:
    ds_read_b32 v10, v2 offset:31760
    s_waitcnt lgkmcnt(0)
    v_cmp_gt_u32 vcc, 10, v10
    s_sub_u32 s79, s79, 1
    s_cbranch_scc1 L_lwd6
    s_cbranch_vccz L_lwd6
    s_sleep 2
    s_branch L_lw6
L_lwd6:
    s_setprio 0
    ds_write_b128 v14, v[84:87] offset:0
    ds_write_b128 v14, v[88:91] offset:1024
    ds_write_b128 v14, v[92:95] offset:2048
    ds_write_b128 v14, v[96:99] offset:3072
    ds_write_b128 v14, v[100:103] offset:4096
    ds_write_b128 v14, v[104:107] offset:5120
    ds_write_b128 v14, v[108:111] offset:6144
    ds_write_b128 v14, v[112:115] offset:7168
    s_mov_b64 exec, 1
    ds_write_b32 v3, v21 offset:31744
    s_mov_b64 exec, -1
    s_setprio 3
    s_mov_b32 s79, 400000
L_lw7:
    ds_read_b32 v10, v2 offset:31760
    s_waitcnt lgkmcnt(0)
    v_cmp_gt_u32 vcc, 11, v10
    s_sub_u32 s79, s79, 1
    s_cbranch_scc1 L_lwd7
    s_cbranch_vccz L_lwd7
    s_sleep 2
    s_branch L_lw7
L_lwd7:
    s_setprio 0
    ds_write_b128 v14, v[116:119] offset:32768
    ds_write_b128 v14, v[120:123] offset:33792
    ds_write_b128 v14, v[124:127] offset:34816
    ds_write_b128 v14, v[128:131] offset:35840
    ds_write_b128 v14, v[132:135] offset:36864
    ds_write_b128 v14, v[136:139] offset:37888
    ds_write_b128 v14, v[140:143] offset:38912
    ds_write_b128 v14, v[144:147] offset:39936
    s_mov_b64 exec, 1
    ds_write_b32 v3, v22 offset:31744
    s_mov_b64 exec, -1
    s_setprio 3
    s_mov_b32 s79, 400000
L_lw8:
    ds_read_b32 v10, v2 offset:31760
    s_waitcnt lgkmcnt(0)
    v_cmp_gt_u32 vcc, 12, v10
    s_sub_u32 s79, s79, 1
    s_cbranch_scc1 L_lwd8
    s_cbranch_vccz L_lwd8
    s_sleep 2
    s_branch L_lw8
L_lwd8:
    s_waitcnt vmcnt(0)
    ds_write_b128 v166, v[24:27] offset:32768
    ds_write_b128 v166, v[28:31] offset:33792
    s_mov_b64 exec, 1
    ds_write_b32 v3, v17 offset:31824
    s_mov_b64 exec, -1
    s_endpgm
L_Dln2:
    v_lshlrev_b32 v11, 7, v0
    s_sleep 12
    s_lshl_b32 s64, s40, 2
    s_add_u32 s64, s64, s42
    s_mul_i32 s64, s64, 14336
    buffer_load_dword v12, v11, s[56:59], s64 offen
    s_add_u32 s64, s64, 8192
    s_mov_b32 exec_hi, 0xffff
    buffer_load_dword v12, v11, s[56:59], s64 offen
    s_mov_b64 exec, -1
    s_barrier
    s_lshl_b32 s64, s4, 2
    s_add_u32 s64, s64, s42
    s_mul_i32 s64, s64, 114688
    s_add_u32 s64, s64, 384
    v_lshlrev_b32 v13, 10, v0
    s_waitcnt vmcnt(1)
    buffer_load_dword v12, v13, s[56:59], s64 offen
    s_add_u32 s64, s64, 0x10000
    s_mov_b32 exec_hi, 0xffff
    s_waitcnt vmcnt(1)
    buffer_load_dword v12, v13, s[56:59], s64 offen
    s_mov_b64 exec, -1
    s_mul_i32 s70, s67, 0x00020000
    s_add_u32 s70, s70, s76
    s_add_u32 s70, s70, 163840
    s_waitcnt vmcnt(9)
    buffer_load_dwordx4 v[52:55], v7, s[56:59], s70 offen
    s_add_u32 s70, s70, 8192
    s_waitcnt vmcnt(9)
    buffer_load_dwordx4 v[56:59], v7, s[56:59], s70 offen
    s_add_u32 s70, s70, 8192
    s_waitcnt vmcnt(9)
    buffer_load_dwordx4 v[60:63], v7, s[56:59], s70 offen
    s_add_u32 s70, s70, 8192
    s_waitcnt vmcnt(9)
    buffer_load_dwordx4 v[64:67], v7, s[56:59], s70 offen
    s_add_u32 s70, s70, 40960
    s_waitcnt vmcnt(9)
    buffer_load_dwordx4 v[68:71], v7, s[56:59], s70 offen
    s_add_u32 s70, s70, 8192
    s_waitcnt vmcnt(9)
    buffer_load_dwordx4 v[72:75], v7, s[56:59], s70 offen
    s_add_u32 s70, s70, 8192
    s_waitcnt vmcnt(9)
    buffer_load_dwordx4 v[76:79], v7, s[56:59], s70 offen
    s_add_u32 s70, s70, 8192
    s_waitcnt vmcnt(9)
    buffer_load_dwordx4 v[80:83], v7, s[56:59], s70 offen
    s_mul_i32 s70, s67, 0x00020000
    s_add_u32 s70, s70, s76
    s_add_u32 s70, s70, 425984
    s_waitcnt vmcnt(9)
    buffer_load_dwordx4 v[84:87], v7, s[56:59], s70 offen
    s_add_u32 s70, s70, 8192
    s_waitcnt vmcnt(9)
    buffer_load_dwordx4 v[88:91], v7, s[56:59], s70 offen
    s_add_u32 s70, s70, 8192
    s_waitcnt vmcnt(9)
    buffer_load_dwordx4 v[92:95], v7, s[56:59], s70 offen
    s_add_u32 s70, s70, 8192
    s_waitcnt vmcnt(9)
    buffer_load_dwordx4 v[96:99], v7, s[56:59], s70 offen
    s_add_u32 s70, s70, 40960
    s_waitcnt vmcnt(9)
    buffer_load_dwordx4 v[100:103], v7, s[56:59], s70 offen
    s_add_u32 s70, s70, 8192
    s_waitcnt vmcnt(9)
    buffer_load_dwordx4 v[104:107], v7, s[56:59], s70 offen
    s_add_u32 s70, s70, 8192
    s_waitcnt vmcnt(9)
    buffer_load_dwordx4 v[108:111], v7, s[56:59], s70 offen
    s_add_u32 s70, s70, 8192
    s_waitcnt vmcnt(9)
    buffer_load_dwordx4 v[112:115], v7, s[56:59], s70 offen
    s_mul_i32 s70, s67, 0x00020000
    s_add_u32 s70, s70, s76
    s_add_u32 s70, s70, 688128
    s_waitcnt vmcnt(9)
    buffer_load_dwordx4 v[116:119], v7, s[56:59], s70 offen
    s_add_u32 s70, s70, 8192
    s_waitcnt vmcnt(9)
    buffer_load_dwordx4 v[120:123], v7, s[56:59], s70 offen
    s_add_u32 s70, s70, 8192
    s_waitcnt vmcnt(9)
    buffer_load_dwordx4 v[124:127], v7, s[56:59], s70 offen
    s_add_u32 s70, s70, 8192
    s_waitcnt vmcnt(9)
    buffer_load_dwordx4 v[128:131], v7, s[56:59], s70 offen
    s_add_u32 s70, s70, 40960
    s_waitcnt vmcnt(9)
    buffer_load_dwordx4 v[132:135], v7, s[56:59], s70 offen
    s_add_u32 s70, s70, 8192
    s_waitcnt vmcnt(9)
    buffer_load_dwordx4 v[136:139], v7, s[56:59], s70 offen
    s_add_u32 s70, s70, 8192
    s_waitcnt vmcnt(9)
    buffer_load_dwordx4 v[140:143], v7, s[56:59], s70 offen
    s_add_u32 s70, s70, 8192
    s_waitcnt vmcnt(9)
    buffer_load_dwordx4 v[144:147], v7, s[56:59], s70 offen
    s_mov_b32 s79, 400000
L_lw9:
    ds_read_b32 v10, v2 offset:31792
    s_waitcnt lgkmcnt(0)
    v_cmp_gt_u32 vcc, 4, v10
    s_sub_u32 s79, s79, 1
    s_cbranch_scc1 L_lwd9
    s_cbranch_vccz L_lwd9
    s_sleep 1
    s_branch L_lw9
L_lwd9:
    s_mov_b32 s48, s32
    s_mov_b32 s49, s33
    s_mov_b32 s50, 0x00000100
    s_mov_b32 s51, 0x20000
    s_mul_i32 s70, s67, 0x00020000
    s_add_u32 s70, s70, s76
    s_add_u32 s70, s70, 0
    s_add_u32 m0, s77, 32768
    s_waitcnt vmcnt(9)
    buffer_load_dwordx4 v7, s[56:59], s70 offen offset:0 lds
    s_add_u32 s70, s70, 7168
    s_waitcnt vmcnt(9)
    buffer_load_dwordx4 v7, s[56:59], s70 offen offset:1024 lds
    s_add_u32 s70, s70, 7168
    s_waitcnt vmcnt(9)
    buffer_load_dwordx4 v7, s[56:59], s70 offen offset:2048 lds
    s_add_u32 s70, s70, 7168
    s_waitcnt vmcnt(9)
    buffer_load_dwordx4 v7, s[56:59], s70 offen offset:3072 lds
    s_add_u32 s70, s70, 44032
    s_add_u32 m0, m0, 0x1000
    s_waitcnt vmcnt(9)
    buffer_load_dwordx4 v7, s[56:59], s70 offen offset:0 lds
    s_add_u32 s70, s70, 7168
    s_waitcnt vmcnt(9)
    buffer_load_dwordx4 v7, s[56:59], s70 offen offset:1024 lds
    s_add_u32 s70, s70, 7168
    s_waitcnt vmcnt(9)
    buffer_load_dwordx4 v7, s[56:59], s70 offen offset:2048 lds
    s_add_u32 s70, s70, 7168
    s_waitcnt vmcnt(9)
    buffer_load_dwordx4 v7, s[56:59], s70 offen offset:3072 lds
    s_load_dword s63, s[32:33], 0
    s_load_dwordx4 s[16:19], s[20:21], 0
    s_mul_i32 s70, s67, 0x00020000
    s_add_u32 s70, s70, s76
    s_add_u32 s70, s70, 262144
    s_add_u32 m0, s77, 65536
    s_waitcnt vmcnt(9)
    buffer_load_dwordx4 v7, s[56:59], s70 offen offset:0 lds
    s_add_u32 s70, s70, 7168
    s_waitcnt vmcnt(9)
    buffer_load_dwordx4 v7, s[56:59], s70 offen offset:1024 lds
    s_add_u32 s70, s70, 7168
    s_waitcnt vmcnt(9)
    buffer_load_dwordx4 v7, s[56:59], s70 offen offset:2048 lds
    s_add_u32 s70, s70, 7168
    s_waitcnt vmcnt(9)
    buffer_load_dwordx4 v7, s[56:59], s70 offen offset:3072 lds
    s_add_u32 s70, s70, 44032
    s_add_u32 m0, m0, 0x1000
    s_waitcnt vmcnt(9)
    buffer_load_dwordx4 v7, s[56:59], s70 offen offset:0 lds
    s_add_u32 s70, s70, 7168
    s_waitcnt vmcnt(9)
    buffer_load_dwordx4 v7, s[56:59], s70 offen offset:1024 lds
    s_add_u32 s70, s70, 7168
    s_waitcnt vmcnt(9)
    buffer_load_dwordx4 v7, s[56:59], s70 offen offset:2048 lds
    s_add_u32 s70, s70, 7168
    s_waitcnt vmcnt(9)
    buffer_load_dwordx4 v7, s[56:59], s70 offen offset:3072 lds
    s_waitcnt lgkmcnt(0)
    s_cmp_lg_u32 s63, 0
    s_cbranch_scc1 L_tf10
    v_mov_b32 v10, 0
    s_mov_b64 exec, 1
    s_mov_b32 s79, 100000
L_poll11:
    buffer_load_dword v11, v10, s[48:51], 0 offen sc1
    s_waitcnt vmcnt(0)
    v_cmp_eq_u32 vcc, 0, v11
    s_sub_u32 s79, s79, 1
    s_cbranch_scc1 L_polled11
    s_cmp_eq_u64 vcc, 0
    s_cbranch_scc1 L_polled11
    s_sleep 8
    s_branch L_poll11
L_polled11:
    s_mov_b64 exec, -1
    v_readfirstlane_b32 s63, v11
    s_nop 1
L_tf10:
    s_waitcnt lgkmcnt(0)
    s_mov_b32 s62, 0
    s_xor_b32 s16, s16, s63
    s_or_b32 s62, s62, s16
    s_xor_b32 s17, s17, s63
    s_or_b32 s62, s62, s17
    s_xor_b32 s18, s18, s63
    s_or_b32 s62, s62, s18
    s_xor_b32 s19, s19, s63
    s_or_b32 s62, s62, s19
    s_cbranch_scc0 L_hxf
    s_sleep 8
    s_mov_b64 exec, 15
    s_mov_b32 s79, 100000
L_poll12:
    buffer_load_dword v15, v167, s[44:47], 0 offen sc1
    s_waitcnt vmcnt(0)
    v_cmp_ne_u32 vcc, s63, v15
    s_sub_u32 s79, s79, 1
    s_cbranch_scc1 L_polled12
    s_cmp_eq_u64 vcc, 0
    s_cbranch_scc1 L_polled12
    s_sleep 12
    s_branch L_poll12
L_polled12:
    s_mov_b64 exec, -1
L_hxf:
    s_add_u32 s65, s73, 263168
    buffer_load_dwordx4 v[24:27], v164, s[44:47], s73 offen sc1
    buffer_load_dwordx4 v[28:31], v164, s[44:47], s65 offen sc1
    buffer_load_dwordx4 v[32:35], v165, s[44:47], 0 offen offset:0 sc1
    buffer_load_dwordx4 v[36:39], v165, s[44:47], 0 offen offset:16 sc1
    buffer_load_dwordx4 v[40:43], v165, s[44:47], 0 offen offset:2048 sc1
    buffer_load_dwordx4 v[44:47], v165, s[44:47], 0 offen offset:2064 sc1
    s_mul_i32 s70, s67, 0x00020000
    s_add_u32 s70, s70, s76
    s_add_u32 s70, s70, 524288
    s_add_u32 m0, s77, 98304
    s_nop 0
    buffer_load_dwordx4 v7, s[56:59], s70 offen offset:0 lds
    s_add_u32 s70, s70, 7168
    buffer_load_dwordx4 v7, s[56:59], s70 offen offset:1024 lds
    s_add_u32 s70, s70, 7168
    buffer_load_dwordx4 v7, s[56:59], s70 offen offset:2048 lds
    s_add_u32 s70, s70, 7168
    buffer_load_dwordx4 v7, s[56:59], s70 offen offset:3072 lds
    s_add_u32 s70, s70, 44032
    s_add_u32 m0, m0, 0x1000
    s_nop 0
    buffer_load_dwordx4 v7, s[56:59], s70 offen offset:0 lds
    s_add_u32 s70, s70, 7168
    buffer_load_dwordx4 v7, s[56:59], s70 offen offset:1024 lds
    s_add_u32 s70, s70, 7168
    buffer_load_dwordx4 v7, s[56:59], s70 offen offset:2048 lds
    s_add_u32 s70, s70, 7168
    buffer_load_dwordx4 v7, s[56:59], s70 offen offset:3072 lds
    s_mul_i32 s70, s67, 0xfff48000
    s_add_u32 s70, s70, s76
    s_add_u32 s70, s70, 786432
    s_add_u32 m0, s77, 0
    s_nop 0
    buffer_load_dwordx4 v7, s[56:59], s70 offen offset:0 lds
    s_add_u32 s70, s70, 7168
    buffer_load_dwordx4 v7, s[56:59], s70 offen offset:1024 lds
    s_add_u32 s70, s70, 7168
    buffer_load_dwordx4 v7, s[56:59], s70 offen offset:2048 lds
    s_add_u32 s70, s70, 7168
    buffer_load_dwordx4 v7, s[56:59], s70 offen offset:3072 lds
    s_add_u32 s70, s70, 44032
    s_add_u32 m0, m0, 0x1000
    s_nop 0
    buffer_load_dwordx4 v7, s[56:59], s70 offen offset:0 lds
    s_add_u32 s70, s70, 7168
    buffer_load_dwordx4 v7, s[56:59], s70 offen offset:1024 lds
    s_add_u32 s70, s70, 7168
    buffer_load_dwordx4 v7, s[56:59], s70 offen offset:2048 lds
    s_add_u32 s70, s70, 7168
    buffer_load_dwordx4 v7, s[56:59], s70 offen offset:3072 lds
    s_mov_b32 s62, 0xffff0000
    s_waitcnt vmcnt(16)
    s_setprio 1
    s_mov_b32 s79, 100000
L_tagh:
    v_xor_b32 v48, s63, v33
    v_xor_b32 v35, s63, v35
    v_xor_b32 v49, s63, v37
    v_xor_b32 v39, s63, v39
    v_xor_b32 v50, s63, v41
    v_xor_b32 v43, s63, v43
    v_xor_b32 v51, s63, v45
    v_xor_b32 v47, s63, v47
    v_or3_b32 v48, v48, v49, v50
    v_or3_b32 v48, v48, v51, v35
    v_or3_b32 v48, v48, v39, v43
    v_or_b32 v48, v48, v47
    v_cmp_ne_u32 vcc, 0, v48
    s_sub_u32 s79, s79, 1
    s_cbranch_scc1 L_tagdh
    s_cbranch_vccz L_tagdh
    s_sleep 12
    buffer_load_dwordx4 v[32:35], v165, s[44:47], 0 offen offset:0 sc1
    buffer_load_dwordx4 v[36:39], v165, s[44:47], 0 offen offset:16 sc1
    buffer_load_dwordx4 v[40:43], v165, s[44:47], 0 offen offset:2048 sc1
    buffer_load_dwordx4 v[44:47], v165, s[44:47], 0 offen offset:2064 sc1
    s_waitcnt vmcnt(0)
    s_branch L_tagh
L_tagdh:
    v_lshlrev_b32 v33, 16, v32
    v_and_b32 v32, s62, v32
    v_lshlrev_b32 v35, 16, v34
    v_and_b32 v34, s62, v34
    v_lshlrev_b32 v37, 16, v36
    v_and_b32 v36, s62, v36
    v_lshlrev_b32 v39, 16, v38
    v_and_b32 v38, s62, v38
    v_rcp_f32 v32, v32
    v_rcp_f32 v34, v34
    v_rcp_f32 v36, v36
    v_rcp_f32 v38, v38
    v_lshlrev_b32 v48, 16, v24
    v_and_b32 v49, s62, v24
    v_sub_f32 v48, v48, v33
    v_sub_f32 v49, v49, v35
    v_cvt_pk_bf16_f32 v24, v48, v49
    v_lshlrev_b32 v48, 16, v24
    v_and_b32 v49, s62, v24
    v_mul_f32 v48, v48, v32
    v_mul_f32 v49, v49, v34
    v_cvt_pk_bf16_f32 v24, v48, v49
    v_lshlrev_b32 v48, 16, v25
    v_and_b32 v49, s62, v25
    v_sub_f32 v48, v48, v37
    v_sub_f32 v49, v49, v39
    v_cvt_pk_bf16_f32 v25, v48, v49
    v_lshlrev_b32 v48, 16, v25
    v_and_b32 v49, s62, v25
    v_mul_f32 v48, v48, v36
    v_mul_f32 v49, v49, v38
    v_cvt_pk_bf16_f32 v25, v48, v49
    v_lshlrev_b32 v48, 16, v26
    v_and_b32 v49, s62, v26
    v_sub_f32 v48, v48, v33
    v_sub_f32 v49, v49, v35
    v_cvt_pk_bf16_f32 v26, v48, v49
    v_lshlrev_b32 v48, 16, v26
    v_and_b32 v49, s62, v26
    v_mul_f32 v48, v48, v32
    v_mul_f32 v49, v49, v34
    v_cvt_pk_bf16_f32 v26, v48, v49
    v_lshlrev_b32 v48, 16, v27
    v_and_b32 v49, s62, v27
    v_sub_f32 v48, v48, v37
    v_sub_f32 v49, v49, v39
    v_cvt_pk_bf16_f32 v27, v48, v49
    v_lshlrev_b32 v48, 16, v27
    v_and_b32 v49, s62, v27
    v_mul_f32 v48, v48, v36
    v_mul_f32 v49, v49, v38
    v_cvt_pk_bf16_f32 v27, v48, v49
    v_lshlrev_b32 v41, 16, v40
    v_and_b32 v40, s62, v40
    v_lshlrev_b32 v43, 16, v42
    v_and_b32 v42, s62, v42
    v_lshlrev_b32 v45, 16, v44
    v_and_b32 v44, s62, v44
    v_lshlrev_b32 v47, 16, v46
    v_and_b32 v46, s62, v46
    v_rcp_f32 v40, v40
    v_rcp_f32 v42, v42
    v_rcp_f32 v44, v44
    v_rcp_f32 v46, v46
    v_lshlrev_b32 v48, 16, v28
    v_and_b32 v49, s62, v28
    v_sub_f32 v48, v48, v41
    v_sub_f32 v49, v49, v43
    v_cvt_pk_bf16_f32 v28, v48, v49
    v_lshlrev_b32 v48, 16, v28
    v_and_b32 v49, s62, v28
    v_mul_f32 v48, v48, v40
    v_mul_f32 v49, v49, v42
    v_cvt_pk_bf16_f32 v28, v48, v49
    v_lshlrev_b32 v48, 16, v29
    v_and_b32 v49, s62, v29
    v_sub_f32 v48, v48, v45
    v_sub_f32 v49, v49, v47
    v_cvt_pk_bf16_f32 v29, v48, v49
    v_lshlrev_b32 v48, 16, v29
    v_and_b32 v49, s62, v29
    v_mul_f32 v48, v48, v44
    v_mul_f32 v49, v49, v46
    v_cvt_pk_bf16_f32 v29, v48, v49
    v_lshlrev_b32 v48, 16, v30
    v_and_b32 v49, s62, v30
    v_sub_f32 v48, v48, v41
    v_sub_f32 v49, v49, v43
    v_cvt_pk_bf16_f32 v30, v48, v49
    v_lshlrev_b32 v48, 16, v30
    v_and_b32 v49, s62, v30
    v_mul_f32 v48, v48, v40
    v_mul_f32 v49, v49, v42
    v_cvt_pk_bf16_f32 v30, v48, v49
    v_lshlrev_b32 v48, 16, v31
    v_and_b32 v49, s62, v31
    v_sub_f32 v48, v48, v45
    v_sub_f32 v49, v49, v47
    v_cvt_pk_bf16_f32 v31, v48, v49
    v_lshlrev_b32 v48, 16, v31
    v_and_b32 v49, s62, v31
    v_mul_f32 v48, v48, v44
    v_mul_f32 v49, v49, v46
    v_cvt_pk_bf16_f32 v31, v48, v49
    ds_write_b128 v166, v[24:27] offset:17920
    ds_write_b128 v166, v[28:31] offset:18944
    s_mov_b64 exec, 1
    ds_write_b32 v3, v16 offset:31824
    s_mov_b64 exec, -1
    s_waitcnt vmcnt(0)
    s_mov_b64 exec, 1
    ds_write_b32 v3, v19 offset:31744
    s_mov_b64 exec, -1
    s_branch L_Dtail
L_L:
    s_setprio 1
    s_mov_b32 s44, s34
    s_mov_b32 s45, s35
    s_mov_b32 s46, 0x10000000
    s_mov_b32 s47, 0x20000
    s_mov_b32 s48, s32
    s_mov_b32 s49, s33
    s_mov_b32 s50, 0x00000100
    s_mov_b32 s51, 0x20000
    v_bfe_u32 v160, v0, 2, 2
    v_and_b32 v161, 3, v0
    v_lshrrev_b32 v162, 4, v0
    v_lshrrev_b32 v163, 5, v0
    v_and_b32 v164, 15, v0
    v_bfe_u32 v165, v0, 4, 1
    v_lshlrev_b32 v2, 2, v161
    s_lshl_b32 s64, s42, 2
    v_mov_b32 v3, s64
    s_cmp_ge_u32 s37, 28
    s_cselect_b32 s64, 8, 0
    v_lshlrev_b32 v8, 2, v0
    v_cmp_gt_u32 vcc, 8, v0
    v_mov_b32 v9, s64
    s_nop 0
    v_cndmask_b32 v9, 0, v9, vcc
    v_mov_b32 v10, 0
    v_mov_b32 v11, 0
    v_lshlrev_b32 v12, 3, v0
    ds_write_b64 v12, v[10:11] offset:17408
    s_mov_b64 exec, 0xffffff
    ds_write_b32 v8, v9 offset:31744
    s_mov_b64 exec, -1
    s_lshl_b32 s64, s42, 7
    v_lshl_add_u32 v5, v6, 2, s64
    s_mov_b32 s72, 0x76543210
    s_mov_b32 s73, 0xcbaaa988
    s_mov_b32 s74, 0x54214310
    s_mov_b32 s75, 0xdcba9876
    v_lshlrev_b32 v9, 2, v164
    v_lshrrev_b64 v[24:25], v9, s[72:73]
    v_lshrrev_b64 v[26:27], v9, s[74:75]
    v_cmp_eq_u32 vcc, 1, v165
    s_nop 1
    v_cndmask_b32 v158, v24, v26, vcc
    v_and_b32 v158, 15, v158
    s_mul_i32 s76, s42, 4352
    v_mul_u32_u24 v158, 272, v158
    v_lshl_add_u32 v158, v163, 4, v158
    v_add_u32 v158, s76, v158
    v_mul_u32_u24 v159, 272, v164
    v_lshl_add_u32 v159, v163, 4, v159
    v_add_u32 v159, s76, v159
    v_and_b32 v12, 1, v0
    v_lshl_add_u32 v12, v12, 4, v160
    v_lshrrev_b32 v13, 1, v160
    v_xor_b32 v13, v13, v162
    v_lshlrev_b32 v12, 7, v12
    v_lshl_add_u32 v12, v13, 4, v12
    s_lshl_b32 s64, s42, 12
    s_add_u32 s64, s64, 65536
    v_bfe_u32 v13, v0, 1, 1
    v_lshl_add_u32 v12, v13, 3, v12
    v_add_u32 v12, s64, v12
    s_mov_b32 s71, s5
    s_lshl_b32 s77, s38, 2
    s_add_u32 s77, s77, s42
    s_mul_i32 s70, s77, 32896
    s_lshl_b32 s64, s71, 12
    s_add_u32 s70, s70, s64
    s_add_u32 s70, s70, 1048576
    s_lshl_b32 s71, s71, 9
    s_lshr_b32 s77, s38, 2
    s_lshl_b32 s77, s77, 7
    s_add_u32 s77, s77, s71
    s_and_b32 s71, s38, 3
    s_lshl_b32 s71, s71, 2
    s_add_u32 s77, s77, s71
    s_add_u32 s77, s77, 4096
    s_mov_b32 s62, 0xffff0000
    v_cmp_eq_u32 vcc, v164, v165
    v_mov_b32 v145, 0x3f803f80
    s_nop 0
    v_cndmask_b32 v144, 0, v145, vcc
    v_mov_b32 v145, v144
    v_mov_b32 v146, v144
    v_mov_b32 v147, v144
    v_mov_b32 v148, 0
    v_mov_b32 v149, 0
    v_mov_b32 v150, 0
    v_mov_b32 v151, 0
    v_lshl_add_u32 v6, v163, 3, v160
    v_lshlrev_b32 v6, 8, v6
    v_xor_b32 v16, s42, v160
    v_lshl_add_u32 v6, v16, 6, v6
    v_lshl_add_u32 v6, v165, 5, v6
    v_lshl_add_u32 v6, v161, 3, v6
    v_add_u32 v6, 81920, v6
    s_mov_b32 s72, 0x3fb8aa3b
    s_mov_b32 s73, 0x32a57060
    s_mov_b32 s74, 0x3f317218
    s_mov_b32 m0, s76
    s_waitcnt vmcnt(4)
    v_lshlrev_b32 v152, 16, v152
    v_lshlrev_b32 v153, 16, v153
    v_lshlrev_b32 v154, 16, v154
    v_mul_f32 v76, s72, v152
    v_fma_f32 v77, v152, s72, -v76
    v_fma_f32 v77, v152, s73, v77
    v_exp_f32 v76, v76
    v_mul_f32 v77, s74, v77
    v_fma_f32 v152, v76, v77, v76
    v_cvt_pk_bf16_f32 v152, v152, v152
    v_and_b32 v152, 0xffff0000, v152
    v_mul_f32 v76, s72, v153
    v_fma_f32 v77, v153, s72, -v76
    v_fma_f32 v77, v153, s73, v77
    v_exp_f32 v76, v76
    v_mul_f32 v77, s74, v77
    v_fma_f32 v153, v76, v77, v76
    v_cvt_pk_bf16_f32 v153, v153, v153
    v_and_b32 v153, 0xffff0000, v153
    v_mul_f32 v153, v153, v152
    v_mul_f32 v154, v154, v152
    v_mul_f32 v153, 0xbfb8aa3b, v153
    v_mul_f32 v154, 0.15915494, v154
    v_mul_f32 v84, 0x41000000, v153
    v_mul_f32 v85, 0x41000000, v154
    v_exp_f32 v84, v84
    v_fract_f32 v85, v85
    v_cos_f32 v76, v85
    v_sin_f32 v78, v85
    v_mul_f32 v76, v76, v84
    v_mul_f32 v78, v78, v84
    v_mul_f32 v84, 0x43000000, v153
    v_mul_f32 v85, 0x43000000, v154
    v_exp_f32 v84, v84
    v_fract_f32 v85, v85
    v_cos_f32 v89, v85
    v_sin_f32 v91, v85
    v_mul_f32 v89, v89, v84
    v_mul_f32 v91, v91, v84
    v_mov_b32 v88, 1.0
    v_mov_b32 v90, 0
.p2align 3
    v_cvt_pk_bf16_f32 v16, v88, v90
    v_cvt_pk_bf16_f32 v32, v89, v91
    v_pk_mul_f32 v[92:93], v[88:89], v[76:77] op_sel_hi:[1,0]
    v_pk_mul_f32 v[94:95], v[90:91], v[76:77] op_sel_hi:[1,0]
    v_pk_fma_f32 v[92:93], v[90:91], v[78:79], v[92:93] op_sel_hi:[1,0,1] neg_lo:[0,1,0] neg_hi:[0,1,0]
    v_pk_fma_f32 v[94:95], v[88:89], v[78:79], v[94:95] op_sel_hi:[1,0,1]
    v_cvt_pk_bf16_f32 v17, v92, v94
    v_cvt_pk_bf16_f32 v33, v93, v95
    v_pk_mul_f32 v[88:89], v[92:93], v[76:77] op_sel_hi:[1,0]
    v_pk_mul_f32 v[90:91], v[94:95], v[76:77] op_sel_hi:[1,0]
    v_pk_fma_f32 v[88:89], v[94:95], v[78:79], v[88:89] op_sel_hi:[1,0,1] neg_lo:[0,1,0] neg_hi:[0,1,0]
    v_pk_fma_f32 v[90:91], v[92:93], v[78:79], v[90:91] op_sel_hi:[1,0,1]
    v_cvt_pk_bf16_f32 v18, v88, v90
    v_cvt_pk_bf16_f32 v34, v89, v91
    v_pk_mul_f32 v[92:93], v[88:89], v[76:77] op_sel_hi:[1,0]
    v_pk_mul_f32 v[94:95], v[90:91], v[76:77] op_sel_hi:[1,0]
    v_pk_fma_f32 v[92:93], v[90:91], v[78:79], v[92:93] op_sel_hi:[1,0,1] neg_lo:[0,1,0] neg_hi:[0,1,0]
    v_pk_fma_f32 v[94:95], v[88:89], v[78:79], v[94:95] op_sel_hi:[1,0,1]
    v_cvt_pk_bf16_f32 v19, v92, v94
    v_cvt_pk_bf16_f32 v35, v93, v95
    v_pk_mul_f32 v[88:89], v[92:93], v[76:77] op_sel_hi:[1,0]
    v_pk_mul_f32 v[90:91], v[94:95], v[76:77] op_sel_hi:[1,0]
    v_pk_fma_f32 v[88:89], v[94:95], v[78:79], v[88:89] op_sel_hi:[1,0,1] neg_lo:[0,1,0] neg_hi:[0,1,0]
    v_pk_fma_f32 v[90:91], v[92:93], v[78:79], v[90:91] op_sel_hi:[1,0,1]
    v_cvt_pk_bf16_f32 v20, v88, v90
    v_cvt_pk_bf16_f32 v36, v89, v91
    v_pk_mul_f32 v[92:93], v[88:89], v[76:77] op_sel_hi:[1,0]
    v_pk_mul_f32 v[94:95], v[90:91], v[76:77] op_sel_hi:[1,0]
    v_pk_fma_f32 v[92:93], v[90:91], v[78:79], v[92:93] op_sel_hi:[1,0,1] neg_lo:[0,1,0] neg_hi:[0,1,0]
    v_pk_fma_f32 v[94:95], v[88:89], v[78:79], v[94:95] op_sel_hi:[1,0,1]
    v_cvt_pk_bf16_f32 v21, v92, v94
    v_cvt_pk_bf16_f32 v37, v93, v95
    v_pk_mul_f32 v[88:89], v[92:93], v[76:77] op_sel_hi:[1,0]
    v_pk_mul_f32 v[90:91], v[94:95], v[76:77] op_sel_hi:[1,0]
    v_pk_fma_f32 v[88:89], v[94:95], v[78:79], v[88:89] op_sel_hi:[1,0,1] neg_lo:[0,1,0] neg_hi:[0,1,0]
    v_pk_fma_f32 v[90:91], v[92:93], v[78:79], v[90:91] op_sel_hi:[1,0,1]
    v_cvt_pk_bf16_f32 v22, v88, v90
    v_cvt_pk_bf16_f32 v38, v89, v91
    v_pk_mul_f32 v[92:93], v[88:89], v[76:77] op_sel_hi:[1,0]
    v_pk_mul_f32 v[94:95], v[90:91], v[76:77] op_sel_hi:[1,0]
    v_pk_fma_f32 v[92:93], v[90:91], v[78:79], v[92:93] op_sel_hi:[1,0,1] neg_lo:[0,1,0] neg_hi:[0,1,0]
    v_pk_fma_f32 v[94:95], v[88:89], v[78:79], v[94:95] op_sel_hi:[1,0,1]
    v_cvt_pk_bf16_f32 v23, v92, v94
    v_cvt_pk_bf16_f32 v39, v93, v95
    v_pk_mul_f32 v[88:89], v[92:93], v[76:77] op_sel_hi:[1,0]
    v_pk_mul_f32 v[90:91], v[94:95], v[76:77] op_sel_hi:[1,0]
    v_pk_fma_f32 v[88:89], v[94:95], v[78:79], v[88:89] op_sel_hi:[1,0,1] neg_lo:[0,1,0] neg_hi:[0,1,0]
    v_pk_fma_f32 v[90:91], v[92:93], v[78:79], v[90:91] op_sel_hi:[1,0,1]
    v_cvt_pk_bf16_f32 v24, v88, v90
    v_cvt_pk_bf16_f32 v40, v89, v91
    v_pk_mul_f32 v[92:93], v[88:89], v[76:77] op_sel_hi:[1,0]
    v_pk_mul_f32 v[94:95], v[90:91], v[76:77] op_sel_hi:[1,0]
    v_pk_fma_f32 v[92:93], v[90:91], v[78:79], v[92:93] op_sel_hi:[1,0,1] neg_lo:[0,1,0] neg_hi:[0,1,0]
    v_pk_fma_f32 v[94:95], v[88:89], v[78:79], v[94:95] op_sel_hi:[1,0,1]
    v_cvt_pk_bf16_f32 v25, v92, v94
    v_cvt_pk_bf16_f32 v41, v93, v95
    v_pk_mul_f32 v[88:89], v[92:93], v[76:77] op_sel_hi:[1,0]
    v_pk_mul_f32 v[90:91], v[94:95], v[76:77] op_sel_hi:[1,0]
    v_pk_fma_f32 v[88:89], v[94:95], v[78:79], v[88:89] op_sel_hi:[1,0,1] neg_lo:[0,1,0] neg_hi:[0,1,0]
    v_pk_fma_f32 v[90:91], v[92:93], v[78:79], v[90:91] op_sel_hi:[1,0,1]
    v_cvt_pk_bf16_f32 v26, v88, v90
    v_cvt_pk_bf16_f32 v42, v89, v91
    v_pk_mul_f32 v[92:93], v[88:89], v[76:77] op_sel_hi:[1,0]
    v_pk_mul_f32 v[94:95], v[90:91], v[76:77] op_sel_hi:[1,0]
    v_pk_fma_f32 v[92:93], v[90:91], v[78:79], v[92:93] op_sel_hi:[1,0,1] neg_lo:[0,1,0] neg_hi:[0,1,0]
    v_pk_fma_f32 v[94:95], v[88:89], v[78:79], v[94:95] op_sel_hi:[1,0,1]
    v_cvt_pk_bf16_f32 v27, v92, v94
    v_cvt_pk_bf16_f32 v43, v93, v95
    v_pk_mul_f32 v[88:89], v[92:93], v[76:77] op_sel_hi:[1,0]
    v_pk_mul_f32 v[90:91], v[94:95], v[76:77] op_sel_hi:[1,0]
    v_pk_fma_f32 v[88:89], v[94:95], v[78:79], v[88:89] op_sel_hi:[1,0,1] neg_lo:[0,1,0] neg_hi:[0,1,0]
    v_pk_fma_f32 v[90:91], v[92:93], v[78:79], v[90:91] op_sel_hi:[1,0,1]
    v_cvt_pk_bf16_f32 v28, v88, v90
    v_cvt_pk_bf16_f32 v44, v89, v91
    v_pk_mul_f32 v[92:93], v[88:89], v[76:77] op_sel_hi:[1,0]
    v_pk_mul_f32 v[94:95], v[90:91], v[76:77] op_sel_hi:[1,0]
    v_pk_fma_f32 v[92:93], v[90:91], v[78:79], v[92:93] op_sel_hi:[1,0,1] neg_lo:[0,1,0] neg_hi:[0,1,0]
    v_pk_fma_f32 v[94:95], v[88:89], v[78:79], v[94:95] op_sel_hi:[1,0,1]
    v_cvt_pk_bf16_f32 v29, v92, v94
    v_cvt_pk_bf16_f32 v45, v93, v95
    v_pk_mul_f32 v[88:89], v[92:93], v[76:77] op_sel_hi:[1,0]
    v_pk_mul_f32 v[90:91], v[94:95], v[76:77] op_sel_hi:[1,0]
    v_pk_fma_f32 v[88:89], v[94:95], v[78:79], v[88:89] op_sel_hi:[1,0,1] neg_lo:[0,1,0] neg_hi:[0,1,0]
    v_pk_fma_f32 v[90:91], v[92:93], v[78:79], v[90:91] op_sel_hi:[1,0,1]
    v_cvt_pk_bf16_f32 v30, v88, v90
    v_cvt_pk_bf16_f32 v46, v89, v91
    v_pk_mul_f32 v[92:93], v[88:89], v[76:77] op_sel_hi:[1,0]
    v_pk_mul_f32 v[94:95], v[90:91], v[76:77] op_sel_hi:[1,0]
    v_pk_fma_f32 v[92:93], v[90:91], v[78:79], v[92:93] op_sel_hi:[1,0,1] neg_lo:[0,1,0] neg_hi:[0,1,0]
    v_pk_fma_f32 v[94:95], v[88:89], v[78:79], v[94:95] op_sel_hi:[1,0,1]
    v_cvt_pk_bf16_f32 v31, v92, v94
    v_cvt_pk_bf16_f32 v47, v93, v95
    s_waitcnt vmcnt(0)
    v_lshlrev_b32 v155, 16, v155
    v_lshlrev_b32 v156, 16, v156
    v_lshlrev_b32 v166, 16, v166
    v_lshlrev_b32 v167, 16, v167
    v_mul_f32 v167, s72, v167
    ds_write_b32 v5, v167 offset:31232
    v_mul_f32 v84, 0x3f800000, v153
    v_mul_f32 v85, 0x3f800000, v154
    v_exp_f32 v84, v84
    v_fract_f32 v85, v85
    v_cos_f32 v76, v85
    v_sin_f32 v78, v85
    v_mul_f32 v76, v76, v84
    v_mul_f32 v78, v78, v84
    v_mul_f32 v84, 0x43800000, v153
    v_mul_f32 v85, 0x43800000, v154
    v_exp_f32 v84, v84
    v_fract_f32 v85, v85
    v_cos_f32 v80, v85
    v_sin_f32 v82, v85
    v_mul_f32 v80, v80, v84
    v_mul_f32 v82, v82, v84
    v_mul_f32 v84, 0x40800000, v153
    v_mul_f32 v85, 0x40800000, v154
    v_exp_f32 v84, v84
    v_fract_f32 v85, v85
    v_cos_f32 v108, v85
    v_sin_f32 v110, v85
    v_mul_f32 v108, v108, v84
    v_mul_f32 v110, v110, v84
    v_add_f32 v152, v152, v152
    v_mul_f32 v96, v155, v152
    v_mul_f32 v98, v156, v152
    v_mul_f32 v97, v96, v108
    v_mul_f32 v99, v98, v108
    v_fma_f32 v97, -v98, v110, v97
    v_fma_f32 v99, v96, v110, v99
.p2align 3
    v_cvt_pk_bf16_f32 v48, v96, -v98
    v_cvt_pk_bf16_f32 v52, v97, -v99
    v_pk_mul_f32 v[88:89], v[96:97], v[76:77] op_sel_hi:[1,0]
    v_pk_mul_f32 v[90:91], v[98:99], v[76:77] op_sel_hi:[1,0]
    v_pk_fma_f32 v[88:89], v[98:99], v[78:79], v[88:89] op_sel_hi:[1,0,1] neg_lo:[0,1,0] neg_hi:[0,1,0]
    v_pk_fma_f32 v[90:91], v[96:97], v[78:79], v[90:91] op_sel_hi:[1,0,1]
    v_cvt_pk_bf16_f32 v49, v88, -v90
    v_cvt_pk_bf16_f32 v53, v89, -v91
    v_pk_mul_f32 v[100:101], v[88:89], v[76:77] op_sel_hi:[1,0]
    v_pk_mul_f32 v[102:103], v[90:91], v[76:77] op_sel_hi:[1,0]
    v_pk_fma_f32 v[100:101], v[90:91], v[78:79], v[100:101] op_sel_hi:[1,0,1] neg_lo:[0,1,0] neg_hi:[0,1,0]
    v_pk_fma_f32 v[102:103], v[88:89], v[78:79], v[102:103] op_sel_hi:[1,0,1]
    v_cvt_pk_bf16_f32 v50, v100, -v102
    v_cvt_pk_bf16_f32 v54, v101, -v103
    v_pk_mul_f32 v[88:89], v[100:101], v[76:77] op_sel_hi:[1,0]
    v_pk_mul_f32 v[90:91], v[102:103], v[76:77] op_sel_hi:[1,0]
    v_pk_fma_f32 v[88:89], v[102:103], v[78:79], v[88:89] op_sel_hi:[1,0,1] neg_lo:[0,1,0] neg_hi:[0,1,0]
    v_pk_fma_f32 v[90:91], v[100:101], v[78:79], v[90:91] op_sel_hi:[1,0,1]
    v_cvt_pk_bf16_f32 v51, v88, -v90
    v_cvt_pk_bf16_f32 v55, v89, -v91
    v_pk_mul_f32 v[104:105], v[88:89], v[76:77] op_sel_hi:[1,0]
    v_pk_mul_f32 v[106:107], v[90:91], v[76:77] op_sel_hi:[1,0]
    v_pk_fma_f32 v[104:105], v[90:91], v[78:79], v[104:105] op_sel_hi:[1,0,1] neg_lo:[0,1,0] neg_hi:[0,1,0]
    v_pk_fma_f32 v[106:107], v[88:89], v[78:79], v[106:107] op_sel_hi:[1,0,1]
    v_pk_mul_f32 v[108:109], v[100:101], v[80:81] op_sel_hi:[1,0]
    v_pk_mul_f32 v[110:111], v[102:103], v[80:81] op_sel_hi:[1,0]
    v_pk_fma_f32 v[108:109], v[102:103], v[82:83], v[108:109] op_sel_hi:[1,0,1] neg_lo:[0,1,0] neg_hi:[0,1,0]
    v_pk_fma_f32 v[110:111], v[100:101], v[82:83], v[110:111] op_sel_hi:[1,0,1]
    v_cvt_pk_bf16_f32 v57, v108, -v110
    v_cvt_pk_bf16_f32 v59, v109, -v111
    v_pk_mul_f32 v[88:89], v[96:97], v[80:81] op_sel_hi:[1,0]
    v_pk_mul_f32 v[90:91], v[98:99], v[80:81] op_sel_hi:[1,0]
    v_pk_fma_f32 v[88:89], v[98:99], v[82:83], v[88:89] op_sel_hi:[1,0,1] neg_lo:[0,1,0] neg_hi:[0,1,0]
    v_pk_fma_f32 v[90:91], v[96:97], v[82:83], v[90:91] op_sel_hi:[1,0,1]
    v_cvt_pk_bf16_f32 v56, v88, -v90
    v_cvt_pk_bf16_f32 v58, v89, -v91
    v_pk_mul_f32 v[92:93], v[104:105], v[80:81] op_sel_hi:[1,0]
    v_pk_mul_f32 v[94:95], v[106:107], v[80:81] op_sel_hi:[1,0]
    v_pk_fma_f32 v[92:93], v[106:107], v[82:83], v[92:93] op_sel_hi:[1,0,1] neg_lo:[0,1,0] neg_hi:[0,1,0]
    v_pk_fma_f32 v[94:95], v[104:105], v[82:83], v[94:95] op_sel_hi:[1,0,1]
    v_cvt_pk_bf16_f32 v60, v93, -v95
    v_pk_mul_f32 v[96:97], v[88:89], v[80:81] op_sel_hi:[1,0]
    v_pk_mul_f32 v[98:99], v[90:91], v[80:81] op_sel_hi:[1,0]
    v_pk_fma_f32 v[96:97], v[90:91], v[82:83], v[96:97] op_sel_hi:[1,0,1] neg_lo:[0,1,0] neg_hi:[0,1,0]
    v_pk_fma_f32 v[98:99], v[88:89], v[82:83], v[98:99] op_sel_hi:[1,0,1]
    v_cvt_pk_bf16_f32 v61, v96, -v98
    v_cvt_pk_bf16_f32 v62, v97, -v99
    v_pk_mul_f32 v[104:105], v[92:93], v[80:81] op_sel_hi:[1,0]
    v_pk_mul_f32 v[106:107], v[94:95], v[80:81] op_sel_hi:[1,0]
    v_pk_fma_f32 v[104:105], v[94:95], v[82:83], v[104:105] op_sel_hi:[1,0,1] neg_lo:[0,1,0] neg_hi:[0,1,0]
    v_pk_fma_f32 v[106:107], v[92:93], v[82:83], v[106:107] op_sel_hi:[1,0,1]
    v_cvt_pk_bf16_f32 v63, v105, -v107
    v_pk_mul_f32 v[88:89], v[96:97], v[80:81] op_sel_hi:[1,0]
    v_pk_mul_f32 v[90:91], v[98:99], v[80:81] op_sel_hi:[1,0]
    v_pk_fma_f32 v[88:89], v[98:99], v[82:83], v[88:89] op_sel_hi:[1,0,1] neg_lo:[0,1,0] neg_hi:[0,1,0]
    v_pk_fma_f32 v[90:91], v[96:97], v[82:83], v[90:91] op_sel_hi:[1,0,1]
    v_cvt_pk_bf16_f32 v64, v88, -v90
    v_cvt_pk_bf16_f32 v65, v89, -v91
    v_pk_mul_f32 v[92:93], v[104:105], v[80:81] op_sel_hi:[1,0]
    v_pk_mul_f32 v[94:95], v[106:107], v[80:81] op_sel_hi:[1,0]
    v_pk_fma_f32 v[92:93], v[106:107], v[82:83], v[92:93] op_sel_hi:[1,0,1] neg_lo:[0,1,0] neg_hi:[0,1,0]
    v_pk_fma_f32 v[94:95], v[104:105], v[82:83], v[94:95] op_sel_hi:[1,0,1]
    v_cvt_pk_bf16_f32 v66, v93, -v95
    v_mov_b32 v92, v88
    v_mov_b32 v94, v90
    v_pk_mul_f32 v[88:89], v[92:93], v[80:81] op_sel_hi:[1,0]
    v_pk_mul_f32 v[90:91], v[94:95], v[80:81] op_sel_hi:[1,0]
    v_pk_fma_f32 v[88:89], v[94:95], v[82:83], v[88:89] op_sel_hi:[1,0,1] neg_lo:[0,1,0] neg_hi:[0,1,0]
    v_pk_fma_f32 v[90:91], v[92:93], v[82:83], v[90:91] op_sel_hi:[1,0,1]
    v_cvt_pk_bf16_f32 v67, v88, -v90
    v_cvt_pk_bf16_f32 v71, v89, -v91
    v_pk_mul_f32 v[92:93], v[88:89], v[80:81] op_sel_hi:[1,0]
    v_pk_mul_f32 v[94:95], v[90:91], v[80:81] op_sel_hi:[1,0]
    v_pk_fma_f32 v[92:93], v[90:91], v[82:83], v[92:93] op_sel_hi:[1,0,1] neg_lo:[0,1,0] neg_hi:[0,1,0]
    v_pk_fma_f32 v[94:95], v[88:89], v[82:83], v[94:95] op_sel_hi:[1,0,1]
    v_cvt_pk_bf16_f32 v68, v92, -v94
    v_cvt_pk_bf16_f32 v72, v93, -v95
    v_pk_mul_f32 v[88:89], v[92:93], v[80:81] op_sel_hi:[1,0]
    v_pk_mul_f32 v[90:91], v[94:95], v[80:81] op_sel_hi:[1,0]
    v_pk_fma_f32 v[88:89], v[94:95], v[82:83], v[88:89] op_sel_hi:[1,0,1] neg_lo:[0,1,0] neg_hi:[0,1,0]
    v_pk_fma_f32 v[90:91], v[92:93], v[82:83], v[90:91] op_sel_hi:[1,0,1]
    v_cvt_pk_bf16_f32 v69, v88, -v90
    v_cvt_pk_bf16_f32 v73, v89, -v91
    v_pk_mul_f32 v[92:93], v[88:89], v[80:81] op_sel_hi:[1,0]
    v_pk_mul_f32 v[94:95], v[90:91], v[80:81] op_sel_hi:[1,0]
    v_pk_fma_f32 v[92:93], v[90:91], v[82:83], v[92:93] op_sel_hi:[1,0,1] neg_lo:[0,1,0] neg_hi:[0,1,0]
    v_pk_fma_f32 v[94:95], v[88:89], v[82:83], v[94:95] op_sel_hi:[1,0,1]
    v_cvt_pk_bf16_f32 v70, v92, -v94
    v_cvt_pk_bf16_f32 v74, v93, -v95
    s_waitcnt lgkmcnt(0)
    s_barrier
    s_load_dword s63, s[32:33], 0
    ds_read_b32 v14, v8 offset:31840
    s_cmp_ge_u32 s37, 16
    s_cbranch_scc1 L_noxt
    v_xor_b32 v9, 32, v12
    v_xor_b32 v10, 64, v12
    v_xor_b32 v11, 0x60, v12
    ds_read_b64_tr_b16 v[112:113], v12 offset:0
    ds_read_b64_tr_b16 v[114:115], v9 offset:512
    ds_read_b64_tr_b16 v[116:117], v10 offset:1024
    ds_read_b64_tr_b16 v[118:119], v11 offset:1536
    ds_read_b64_tr_b16 v[120:121], v10 offset:0
    ds_read_b64_tr_b16 v[122:123], v11 offset:512
    ds_read_b64_tr_b16 v[124:125], v12 offset:1024
    ds_read_b64_tr_b16 v[126:127], v9 offset:1536
    ds_read_b64_tr_b16 v[76:77], v6 offset:0
    ds_read_b64_tr_b16 v[78:79], v6 offset:1024
    ds_read_b64_tr_b16 v[80:81], v6 offset:4096
    ds_read_b64_tr_b16 v[82:83], v6 offset:5120
    ds_read_b64_tr_b16 v[84:85], v6 offset:8192
    ds_read_b64_tr_b16 v[86:87], v6 offset:9216
    ds_read_b64_tr_b16 v[88:89], v6 offset:12288
    ds_read_b64_tr_b16 v[90:91], v6 offset:13312
    v_add_u32 v6, 0x00008000, v6
    s_waitcnt lgkmcnt(12)
    s_mov_b32 vcc_lo, 0x33333333
    s_mov_b32 vcc_hi, 0x33333333
    v_cndmask_b32_dpp v128, v116, v112, vcc quad_perm:[0,1,0,1] row_mask:0xf bank_mask:0xf
    v_cndmask_b32_dpp v129, v117, v113, vcc quad_perm:[0,1,0,1] row_mask:0xf bank_mask:0xf
    v_cndmask_b32_dpp v130, v118, v114, vcc quad_perm:[0,1,0,1] row_mask:0xf bank_mask:0xf
    v_cndmask_b32_dpp v131, v119, v115, vcc quad_perm:[0,1,0,1] row_mask:0xf bank_mask:0xf
    s_not_b64 vcc, vcc
    v_cndmask_b32_dpp v132, v112, v116, vcc quad_perm:[2,3,2,3] row_mask:0xf bank_mask:0xf
    v_cndmask_b32_dpp v133, v113, v117, vcc quad_perm:[2,3,2,3] row_mask:0xf bank_mask:0xf
    v_cndmask_b32_dpp v134, v114, v118, vcc quad_perm:[2,3,2,3] row_mask:0xf bank_mask:0xf
    v_cndmask_b32_dpp v135, v115, v119, vcc quad_perm:[2,3,2,3] row_mask:0xf bank_mask:0xf
    s_mov_b32 vcc_lo, 0x55555555
    s_mov_b32 vcc_hi, 0x55555555
    v_cndmask_b32_dpp v112, v130, v128, vcc quad_perm:[0,0,2,2] row_mask:0xf bank_mask:0xf
    v_cndmask_b32_dpp v113, v131, v129, vcc quad_perm:[0,0,2,2] row_mask:0xf bank_mask:0xf
    v_cndmask_b32_dpp v116, v134, v132, vcc quad_perm:[0,0,2,2] row_mask:0xf bank_mask:0xf
    v_cndmask_b32_dpp v117, v135, v133, vcc quad_perm:[0,0,2,2] row_mask:0xf bank_mask:0xf
    s_not_b64 vcc, vcc
    v_cndmask_b32_dpp v114, v128, v130, vcc quad_perm:[1,1,3,3] row_mask:0xf bank_mask:0xf
    v_cndmask_b32_dpp v115, v129, v131, vcc quad_perm:[1,1,3,3] row_mask:0xf bank_mask:0xf
    buffer_store_dwordx4 v[112:115], v1, s[44:47], s70 offen offset:0 sc1
    v_cndmask_b32_dpp v118, v132, v134, vcc quad_perm:[1,1,3,3] row_mask:0xf bank_mask:0xf
    v_cndmask_b32_dpp v119, v133, v135, vcc quad_perm:[1,1,3,3] row_mask:0xf bank_mask:0xf
    buffer_store_dwordx4 v[116:119], v1, s[44:47], s70 offen offset:1024 sc1
    s_branch L_xtd
L_noxt:
    ds_read_b64_tr_b16 v[76:77], v6 offset:0
    ds_read_b64_tr_b16 v[78:79], v6 offset:1024
    ds_read_b64_tr_b16 v[80:81], v6 offset:4096
    ds_read_b64_tr_b16 v[82:83], v6 offset:5120
    ds_read_b64_tr_b16 v[84:85], v6 offset:8192
    ds_read_b64_tr_b16 v[86:87], v6 offset:9216
    ds_read_b64_tr_b16 v[88:89], v6 offset:12288
    ds_read_b64_tr_b16 v[90:91], v6 offset:13312
    v_add_u32 v6, 0x00008000, v6
L_xtd:
    s_waitcnt lgkmcnt(0)
    s_cmp_ge_u32 s37, 28
    s_cbranch_scc1 L_nb13
    s_barrier
L_nb13:
    ds_read_b64_tr_b16 v[92:93], v6 offset:0
    ds_read_b64_tr_b16 v[94:95], v6 offset:1024
    ds_read_b64_tr_b16 v[96:97], v6 offset:4096
    ds_read_b64_tr_b16 v[98:99], v6 offset:5120
    ds_read_b64_tr_b16 v[100:101], v6 offset:8192
    ds_read_b64_tr_b16 v[102:103], v6 offset:9216
    ds_read_b64_tr_b16 v[104:105], v6 offset:12288
    ds_read_b64_tr_b16 v[106:107], v6 offset:13312
    v_add_u32 v6, 0x00008000, v6
    s_cmp_lg_u32 s63, 0
    s_cbranch_scc1 L_tf14
    v_mov_b32 v15, 0
    s_mov_b64 exec, 1
    s_mov_b32 s79, 100000
L_poll15:
    buffer_load_dword v13, v15, s[48:51], 0 offen sc1
    s_waitcnt vmcnt(0)
    v_cmp_eq_u32 vcc, 0, v13
    s_sub_u32 s79, s79, 1
    s_cbranch_scc1 L_polled15
    s_cmp_eq_u64 vcc, 0
    s_cbranch_scc1 L_polled15
    s_sleep 8
    s_branch L_poll15
L_polled15:
    s_mov_b64 exec, -1
    v_readfirstlane_b32 s63, v13
    s_nop 1
L_tf14:
    s_cmp_lg_u32 s42, 3
    s_cbranch_scc1 L_nost
    s_lshl_b32 s64, s43, 6
    s_add_u32 s64, s64, 131072
    v_mov_b32 v15, s63
    v_lshlrev_b32 v13, 3, v0
    s_mov_b64 exec, 0xff
    buffer_store_dwordx2 v[14:15], v13, s[44:47], s64 offen sc1
    s_mov_b64 exec, -1
L_nost:
    s_cmp_ge_u32 s37, 16
    s_cbranch_scc1 L_noxt2
    s_mov_b32 vcc_lo, 0x33333333
    s_mov_b32 vcc_hi, 0x33333333
    v_cndmask_b32_dpp v136, v124, v120, vcc quad_perm:[0,1,0,1] row_mask:0xf bank_mask:0xf
    v_cndmask_b32_dpp v137, v125, v121, vcc quad_perm:[0,1,0,1] row_mask:0xf bank_mask:0xf
    v_cndmask_b32_dpp v138, v126, v122, vcc quad_perm:[0,1,0,1] row_mask:0xf bank_mask:0xf
    v_cndmask_b32_dpp v139, v127, v123, vcc quad_perm:[0,1,0,1] row_mask:0xf bank_mask:0xf
    s_not_b64 vcc, vcc
    v_cndmask_b32_dpp v140, v120, v124, vcc quad_perm:[2,3,2,3] row_mask:0xf bank_mask:0xf
    v_cndmask_b32_dpp v141, v121, v125, vcc quad_perm:[2,3,2,3] row_mask:0xf bank_mask:0xf
    v_cndmask_b32_dpp v142, v122, v126, vcc quad_perm:[2,3,2,3] row_mask:0xf bank_mask:0xf
    v_cndmask_b32_dpp v143, v123, v127, vcc quad_perm:[2,3,2,3] row_mask:0xf bank_mask:0xf
    s_mov_b32 vcc_lo, 0x55555555
    s_mov_b32 vcc_hi, 0x55555555
    v_cndmask_b32_dpp v120, v138, v136, vcc quad_perm:[0,0,2,2] row_mask:0xf bank_mask:0xf
    v_cndmask_b32_dpp v121, v139, v137, vcc quad_perm:[0,0,2,2] row_mask:0xf bank_mask:0xf
    v_cndmask_b32_dpp v124, v142, v140, vcc quad_perm:[0,0,2,2] row_mask:0xf bank_mask:0xf
    v_cndmask_b32_dpp v125, v143, v141, vcc quad_perm:[0,0,2,2] row_mask:0xf bank_mask:0xf
    s_not_b64 vcc, vcc
    v_cndmask_b32_dpp v122, v136, v138, vcc quad_perm:[1,1,3,3] row_mask:0xf bank_mask:0xf
    v_cndmask_b32_dpp v123, v137, v139, vcc quad_perm:[1,1,3,3] row_mask:0xf bank_mask:0xf
    buffer_store_dwordx4 v[120:123], v1, s[44:47], s70 offen offset:2048 sc1
    v_cndmask_b32_dpp v126, v140, v142, vcc quad_perm:[1,1,3,3] row_mask:0xf bank_mask:0xf
    v_cndmask_b32_dpp v127, v141, v143, vcc quad_perm:[1,1,3,3] row_mask:0xf bank_mask:0xf
    buffer_store_dwordx4 v[124:127], v1, s[44:47], s70 offen offset:3072 sc1
L_noxt2:
    s_setprio 3
    v_mfma_f32_16x16x32_bf16 v[148:151], v[144:147], v[76:79], v[148:151]
    v_mfma_f32_16x16x32_bf16 v[148:151], v[144:147], v[80:83], v[148:151]
    v_mfma_f32_16x16x32_bf16 v[148:151], v[144:147], v[84:87], v[148:151]
    v_mfma_f32_16x16x32_bf16 v[148:151], v[144:147], v[88:91], v[148:151]
    s_setprio 1
    s_waitcnt lgkmcnt(0)
    s_cmp_ge_u32 s37, 28
    s_cbranch_scc1 L_nb16
    s_barrier
L_nb16:
    ds_read_b64_tr_b16 v[76:77], v6 offset:0
    ds_read_b64_tr_b16 v[78:79], v6 offset:1024
    ds_read_b64_tr_b16 v[80:81], v6 offset:4096
    ds_read_b64_tr_b16 v[82:83], v6 offset:5120
    ds_read_b64_tr_b16 v[84:85], v6 offset:8192
    ds_read_b64_tr_b16 v[86:87], v6 offset:9216
    ds_read_b64_tr_b16 v[88:89], v6 offset:12288
    ds_read_b64_tr_b16 v[90:91], v6 offset:13312
    v_add_u32 v6, 0xfffe8000, v6
    s_setprio 3
    v_mfma_f32_16x16x32_bf16 v[148:151], v[144:147], v[92:95], v[148:151]
    v_mfma_f32_16x16x32_bf16 v[148:151], v[144:147], v[96:99], v[148:151]
    v_mfma_f32_16x16x32_bf16 v[148:151], v[144:147], v[100:103], v[148:151]
    v_mfma_f32_16x16x32_bf16 v[148:151], v[144:147], v[104:107], v[148:151]
    s_setprio 1
    s_mul_i32 s64, s66, 8704
    s_add_u32 s64, s64, 8
    v_add_u32 v4, v160, v161
    v_lshlrev_b32 v4, 3, v4
    v_lshl_add_u32 v4, v162, 6, v4
    v_add_u32 v4, s64, v4
    v_lshlrev_b32 v5, 4, v161
    v_lshlrev_b32 v7, 5, v162
    v_sub_u32 v5, v5, v7
    v_lshlrev_b32 v7, 2, v160
    v_sub_u32 v5, v5, v7
    v_add_u32 v5, 0x7c, v5
    s_lshl_b32 s64, s66, 3
    v_lshl_add_u32 v5, v5, 2, s64
    s_waitcnt vmcnt(0)
    s_waitcnt lgkmcnt(0)
    s_cmp_ge_u32 s37, 28
    s_cbranch_scc1 L_nb17
    s_barrier
L_nb17:
    ds_read_b64_tr_b16 v[92:93], v6 offset:0
    ds_read_b64_tr_b16 v[94:95], v6 offset:1024
    ds_read_b64_tr_b16 v[96:97], v6 offset:4096
    ds_read_b64_tr_b16 v[98:99], v6 offset:5120
    ds_read_b64_tr_b16 v[100:101], v6 offset:8192
    ds_read_b64_tr_b16 v[102:103], v6 offset:9216
    ds_read_b64_tr_b16 v[104:105], v6 offset:12288
    ds_read_b64_tr_b16 v[106:107], v6 offset:13312
    v_add_u32 v6, 0x00008000, v6
    s_cmp_ge_u32 s37, 16
    s_cbranch_scc1 L_noxf
    s_cmp_lg_u32 s42, 0
    s_cbranch_scc1 L_noxf
    s_mov_b64 exec, 1
    v_mov_b32 v8, s77
    v_mov_b32 v9, s63
    buffer_store_dword v9, v8, s[44:47], 0 offen sc1
    s_mov_b64 exec, -1
L_noxf:
    s_setprio 3
    v_mfma_f32_16x16x32_bf16 v[148:151], v[144:147], v[76:79], v[148:151]
    v_mfma_f32_16x16x32_bf16 v[148:151], v[144:147], v[80:83], v[148:151]
    v_mfma_f32_16x16x32_bf16 v[148:151], v[144:147], v[84:87], v[148:151]
    v_mfma_f32_16x16x32_bf16 v[148:151], v[144:147], v[88:91], v[148:151]
    s_setprio 1
    s_waitcnt lgkmcnt(0)
    s_cmp_ge_u32 s37, 28
    s_cbranch_scc1 L_nb18
    s_barrier
L_nb18:
    ds_read_b64_tr_b16 v[76:77], v6 offset:0
    ds_read_b64_tr_b16 v[78:79], v6 offset:1024
    ds_read_b64_tr_b16 v[80:81], v6 offset:4096
    ds_read_b64_tr_b16 v[82:83], v6 offset:5120
    ds_read_b64_tr_b16 v[84:85], v6 offset:8192
    ds_read_b64_tr_b16 v[86:87], v6 offset:9216
    ds_read_b64_tr_b16 v[88:89], v6 offset:12288
    ds_read_b64_tr_b16 v[90:91], v6 offset:13312
    v_add_u32 v6, 0x00008000, v6
    s_setprio 3
    v_mfma_f32_16x16x32_bf16 v[148:151], v[144:147], v[92:95], v[148:151]
    v_mfma_f32_16x16x32_bf16 v[148:151], v[144:147], v[96:99], v[148:151]
    v_mfma_f32_16x16x32_bf16 v[148:151], v[144:147], v[100:103], v[148:151]
    v_mfma_f32_16x16x32_bf16 v[148:151], v[144:147], v[104:107], v[148:151]
    s_setprio 1
    s_waitcnt lgkmcnt(0)
    s_cmp_ge_u32 s37, 28
    s_cbranch_scc1 L_nb19
    s_barrier
L_nb19:
    ds_read_b64_tr_b16 v[92:93], v6 offset:0
    ds_read_b64_tr_b16 v[94:95], v6 offset:1024
    ds_read_b64_tr_b16 v[96:97], v6 offset:4096
    ds_read_b64_tr_b16 v[98:99], v6 offset:5120
    ds_read_b64_tr_b16 v[100:101], v6 offset:8192
    ds_read_b64_tr_b16 v[102:103], v6 offset:9216
    ds_read_b64_tr_b16 v[104:105], v6 offset:12288
    ds_read_b64_tr_b16 v[106:107], v6 offset:13312
    v_add_u32 v6, 0x00008000, v6
    s_setprio 3
    v_mfma_f32_16x16x32_bf16 v[148:151], v[144:147], v[76:79], v[148:151]
    v_mfma_f32_16x16x32_bf16 v[148:151], v[144:147], v[80:83], v[148:151]
    v_mfma_f32_16x16x32_bf16 v[148:151], v[144:147], v[84:87], v[148:151]
    v_mfma_f32_16x16x32_bf16 v[148:151], v[144:147], v[88:91], v[148:151]
    s_setprio 1
    s_waitcnt lgkmcnt(0)
    s_cmp_ge_u32 s37, 28
    s_cbranch_scc1 L_nb20
    s_barrier
L_nb20:
    ds_read_b64_tr_b16 v[76:77], v6 offset:0
    ds_read_b64_tr_b16 v[78:79], v6 offset:1024
    ds_read_b64_tr_b16 v[80:81], v6 offset:4096
    ds_read_b64_tr_b16 v[82:83], v6 offset:5120
    ds_read_b64_tr_b16 v[84:85], v6 offset:8192
    ds_read_b64_tr_b16 v[86:87], v6 offset:9216
    ds_read_b64_tr_b16 v[88:89], v6 offset:12288
    ds_read_b64_tr_b16 v[90:91], v6 offset:13312
    v_add_u32 v6, 0xfffe8000, v6
    s_setprio 3
    v_mfma_f32_16x16x32_bf16 v[148:151], v[144:147], v[92:95], v[148:151]
    v_mfma_f32_16x16x32_bf16 v[148:151], v[144:147], v[96:99], v[148:151]
    v_mfma_f32_16x16x32_bf16 v[148:151], v[144:147], v[100:103], v[148:151]
    v_mfma_f32_16x16x32_bf16 v[148:151], v[144:147], v[104:107], v[148:151]
    s_setprio 1
    s_waitcnt lgkmcnt(0)
    s_setprio 3
    v_mfma_f32_16x16x32_bf16 v[148:151], v[144:147], v[76:79], v[148:151]
    v_mfma_f32_16x16x32_bf16 v[148:151], v[144:147], v[80:83], v[148:151]
    v_mfma_f32_16x16x32_bf16 v[148:151], v[144:147], v[84:87], v[148:151]
    v_mfma_f32_16x16x32_bf16 v[148:151], v[144:147], v[88:91], v[148:151]
    s_setprio 1
    s_waitcnt lgkmcnt(0)
    s_cmp_ge_u32 s37, 28
    s_cbranch_scc1 L_nb21
    s_barrier
L_nb21:
    ds_read_b64_tr_b16 v[92:93], v6 offset:0
    ds_read_b64_tr_b16 v[94:95], v6 offset:1024
    ds_read_b64_tr_b16 v[96:97], v6 offset:4096
    ds_read_b64_tr_b16 v[98:99], v6 offset:5120
    ds_read_b64_tr_b16 v[100:101], v6 offset:8192
    ds_read_b64_tr_b16 v[102:103], v6 offset:9216
    ds_read_b64_tr_b16 v[104:105], v6 offset:12288
    ds_read_b64_tr_b16 v[106:107], v6 offset:13312
    v_add_u32 v6, 0x00008000, v6
    s_waitcnt lgkmcnt(0)
    s_setprio 3
    v_mfma_f32_16x16x32_bf16 v[148:151], v[144:147], v[92:95], v[148:151]
    v_mfma_f32_16x16x32_bf16 v[148:151], v[144:147], v[96:99], v[148:151]
    v_mfma_f32_16x16x32_bf16 v[148:151], v[144:147], v[100:103], v[148:151]
    v_mfma_f32_16x16x32_bf16 v[148:151], v[144:147], v[104:107], v[148:151]
    s_setprio 1
    s_lshl_b32 s64, s42, 7
    s_add_u32 s64, s64, 30720
    v_lshl_add_u32 v7, v0, 2, s64
    s_mov_b64 exec, 0xffff
    s_nop 2
    ds_write2_b32 v7, v148, v149 offset0:0 offset1:16
    s_mov_b64 exec, -1
    v_mov_b32 v8, 1
    s_mov_b64 exec, 1
    ds_write_b32 v3, v8 offset:31776
    s_mov_b64 exec, -1
    s_setprio 3
    s_mov_b32 s79, 400000
L_lw22:
    ds_read_b32 v8, v2 offset:31760
    s_waitcnt lgkmcnt(0)
    v_cmp_gt_u32 vcc, 8, v8
    s_sub_u32 s79, s79, 1
    s_cbranch_scc1 L_lwd22
    s_cbranch_vccz L_lwd22
    s_sleep 1
    s_branch L_lw22
L_lwd22:
    ds_write_addtid_b32 v16 offset:0
    ds_write_addtid_b32 v17 offset:272
    ds_write_addtid_b32 v18 offset:544
    ds_write_addtid_b32 v19 offset:816
    ds_write_addtid_b32 v20 offset:1088
    ds_write_addtid_b32 v21 offset:1360
    ds_write_addtid_b32 v22 offset:1632
    ds_write_addtid_b32 v23 offset:1904
    ds_write_addtid_b32 v24 offset:2176
    ds_write_addtid_b32 v25 offset:2448
    ds_write_addtid_b32 v26 offset:2720
    ds_write_addtid_b32 v27 offset:2992
    ds_write_addtid_b32 v28 offset:3264
    ds_write_addtid_b32 v29 offset:3536
    ds_write_addtid_b32 v30 offset:3808
    ds_write_addtid_b32 v31 offset:4080
    s_mov_b32 exec_lo, 0xffff
    s_mov_b32 exec_hi, 0xffff
    ds_read_b128 v[112:115], v159 offset:0
    ds_read_b128 v[116:119], v159 offset:32
    ds_read_b128 v[120:123], v159 offset:64
    ds_read_b128 v[124:127], v159 offset:96
    ds_read_b128 v[128:131], v159 offset:128
    ds_read_b128 v[132:135], v159 offset:160
    ds_read_b128 v[136:139], v159 offset:192
    ds_read_b128 v[140:143], v159 offset:224
    s_mov_b64 exec, -1
    ds_write_addtid_b32 v32 offset:0
    ds_write_addtid_b32 v33 offset:272
    ds_write_addtid_b32 v34 offset:544
    ds_write_addtid_b32 v35 offset:816
    ds_write_addtid_b32 v36 offset:1088
    ds_write_addtid_b32 v37 offset:1360
    ds_write_addtid_b32 v38 offset:1632
    ds_write_addtid_b32 v39 offset:1904
    ds_write_addtid_b32 v40 offset:2176
    ds_write_addtid_b32 v41 offset:2448
    ds_write_addtid_b32 v42 offset:2720
    ds_write_addtid_b32 v43 offset:2992
    ds_write_addtid_b32 v44 offset:3264
    ds_write_addtid_b32 v45 offset:3536
    ds_write_addtid_b32 v46 offset:3808
    ds_write_addtid_b32 v47 offset:4080
    s_mov_b32 exec_lo, 0xffff0000
    s_mov_b32 exec_hi, 0xffff0000
    ds_read_b128 v[112:115], v159 offset:0
    ds_read_b128 v[116:119], v159 offset:32
    ds_read_b128 v[120:123], v159 offset:64
    ds_read_b128 v[124:127], v159 offset:96
    ds_read_b128 v[128:131], v159 offset:128
    ds_read_b128 v[132:135], v159 offset:160
    ds_read_b128 v[136:139], v159 offset:192
    ds_read_b128 v[140:143], v159 offset:224
    s_mov_b64 exec, -1
    ds_write_addtid_b32 v48 offset:0
    ds_write_addtid_b32 v49 offset:272
    ds_write_addtid_b32 v50 offset:544
    ds_write_addtid_b32 v51 offset:816
    ds_write_addtid_b32 v52 offset:1088
    ds_write_addtid_b32 v53 offset:1360
    ds_write_addtid_b32 v54 offset:1632
    ds_write_addtid_b32 v55 offset:1904
    ds_write_addtid_b32 v56 offset:2176
    ds_write_addtid_b32 v57 offset:2448
    ds_write_addtid_b32 v58 offset:2720
    ds_write_addtid_b32 v59 offset:2992
    ds_write_addtid_b32 v60 offset:3264
    s_mov_b32 exec_lo, 0xffff
    s_mov_b32 exec_hi, 0xffff
    ds_read_b128 v[16:19], v158 offset:0
    ds_read_b128 v[20:23], v158 offset:32
    ds_read_b128 v[24:27], v158 offset:64
    ds_read_b128 v[28:31], v158 offset:96
    ds_read_b128 v[32:35], v158 offset:128
    ds_read_b128 v[36:39], v158 offset:160
    ds_read_b128 v[40:43], v158 offset:192
    ds_read_b128 v[44:47], v158 offset:224
    s_mov_b64 exec, -1
    ds_write_addtid_b32 v61 offset:0
    ds_write_addtid_b32 v62 offset:272
    ds_write_addtid_b32 v63 offset:544
    ds_write_addtid_b32 v64 offset:816
    ds_write_addtid_b32 v65 offset:1088
    ds_write_addtid_b32 v66 offset:1360
    ds_write_addtid_b32 v67 offset:1632
    ds_write_addtid_b32 v68 offset:1904
    ds_write_addtid_b32 v69 offset:2176
    ds_write_addtid_b32 v70 offset:2448
    ds_write_addtid_b32 v71 offset:2720
    ds_write_addtid_b32 v72 offset:2992
    ds_write_addtid_b32 v73 offset:3264
    ds_write_addtid_b32 v74 offset:3536
    s_mov_b32 exec_lo, 0xffff0000
    s_mov_b32 exec_hi, 0xffff0000
    ds_read_b128 v[16:19], v158 offset:0
    ds_read_b128 v[20:23], v158 offset:32
    ds_read_b128 v[24:27], v158 offset:64
    ds_read_b128 v[28:31], v158 offset:96
    ds_read_b128 v[32:35], v158 offset:128
    ds_read_b128 v[36:39], v158 offset:160
    ds_read_b128 v[40:43], v158 offset:192
    ds_read_b128 v[44:47], v158 offset:224
    s_mov_b64 exec, -1
    v_mov_b32 v8, 2
    s_mov_b64 exec, 1
    ds_write_b32 v3, v8 offset:31792
    s_mov_b64 exec, -1
    s_waitcnt vmcnt(0)
    s_waitcnt lgkmcnt(8)
    v_mfma_f32_32x32x16_bf16 v[76:91], v[16:19], v[112:115], 0
    s_waitcnt lgkmcnt(7)
    v_mfma_f32_32x32x16_bf16 v[76:91], v[20:23], v[116:119], v[76:91]
    s_waitcnt lgkmcnt(6)
    v_mfma_f32_32x32x16_bf16 v[76:91], v[24:27], v[120:123], v[76:91]
    s_waitcnt lgkmcnt(5)
    v_mfma_f32_32x32x16_bf16 v[76:91], v[28:31], v[124:127], v[76:91]
    s_waitcnt lgkmcnt(4)
    v_mfma_f32_32x32x16_bf16 v[76:91], v[32:35], v[128:131], v[76:91]
    s_waitcnt lgkmcnt(3)
    v_mfma_f32_32x32x16_bf16 v[76:91], v[36:39], v[132:135], v[76:91]
    s_waitcnt lgkmcnt(2)
    v_mfma_f32_32x32x16_bf16 v[76:91], v[40:43], v[136:139], v[76:91]
    s_waitcnt lgkmcnt(1)
    v_mfma_f32_32x32x16_bf16 v[76:91], v[44:47], v[140:143], v[76:91]
    s_mul_i32 s64, s66, 8704
    v_add_u32 v12, s64, v1
    s_cmp_eq_u32 s67, 0
    s_cbranch_scc1 L_kx0
    s_nop 7
    ds_write_b128 v12, v[76:79] offset:4352
    ds_write_b128 v12, v[80:83] offset:5376
    ds_write_b128 v12, v[84:87] offset:6400
    ds_write_b128 v12, v[88:91] offset:7424
    s_branch L_kx1
L_kx0:
    v_and_b32 v13, 31, v0
    v_lshlrev_b32 v13, 4, v13
    v_lshl_add_u32 v13, v163, 3, v13
    v_add_u32 v13, s64, v13
    v_add_u32 v14, 32, v13
    v_cmp_eq_u32 vcc, 0, v0
    s_nop 1
    v_cndmask_b32 v166, 0, v166, vcc
    v_xor_b32 v11, 4, v3
    v_mov_b32 v64, 0
    v_mov_b32 v65, 0
    v_mov_b32 v66, 0
    v_mov_b32 v67, 0
    s_mov_b64 exec, 3
    ds_write_b128 v13, v[64:67] offset:0
    s_mov_b64 exec, -1
    s_mov_b32 s79, 400000
L_lw23:
    ds_read_b32 v8, v11 offset:31792
    s_waitcnt lgkmcnt(0)
    v_cmp_gt_u32 vcc, 4, v8
    s_sub_u32 s79, s79, 1
    s_cbranch_scc1 L_lwd23
    s_cbranch_vccz L_lwd23
    s_sleep 1
    s_branch L_lw23
L_lwd23:
    v_add_f32 v76, v76, v166
    ds_read_b128 v[48:51], v12 offset:4352
    ds_read_b128 v[52:55], v12 offset:5376
    ds_read_b128 v[56:59], v12 offset:6400
    ds_read_b128 v[60:63], v12 offset:7424
    v_cmp_eq_u32 vcc, 1, v163
    s_waitcnt lgkmcnt(0)
    v_add_f32 v76, v76, v48
    v_add_f32 v77, v77, v49
    v_add_f32 v78, v78, v50
    v_add_f32 v79, v79, v51
    v_add_f32 v80, v80, v52
    v_add_f32 v81, v81, v53
    v_add_f32 v82, v82, v54
    v_add_f32 v83, v83, v55
    v_add_f32 v84, v84, v56
    v_add_f32 v85, v85, v57
    v_add_f32 v86, v86, v58
    v_add_f32 v87, v87, v59
    v_add_f32 v88, v88, v60
    v_add_f32 v89, v89, v61
    v_add_f32 v90, v90, v62
    v_add_f32 v91, v91, v63
    v_cvt_pk_bf16_f32 v16, v76, v77
    v_cvt_pk_bf16_f32 v17, v78, v79
    v_cvt_pk_bf16_f32 v18, v80, v81
    v_cvt_pk_bf16_f32 v19, v82, v83
    v_cndmask_b32 v36, v84, v85, vcc
    v_cvt_pk_bf16_f32 v20, v84, v84
    v_cvt_pk_bf16_f32 v21, v36, v85
    v_cndmask_b32 v36, v86, v87, vcc
    v_cvt_pk_bf16_f32 v22, v86, v86
    v_cvt_pk_bf16_f32 v23, v36, v87
    v_cvt_pk_bf16_f32 v24, v88, v88
    v_mov_b32 v25, v24
    v_cvt_pk_bf16_f32 v26, v89, v89
    v_mov_b32 v27, v26
    v_cvt_pk_bf16_f32 v28, v90, v90
    v_mov_b32 v29, v28
    v_cvt_pk_bf16_f32 v30, v91, v91
    v_mov_b32 v31, v30
    ds_write2st64_b64 v14, v[16:17], v[18:19] offset0:0 offset1:1
    ds_write2st64_b64 v14, v[20:21], v[22:23] offset0:2 offset1:3
    ds_write2st64_b64 v14, v[24:25], v[26:27] offset0:4 offset1:5
    ds_write2st64_b64 v14, v[28:29], v[30:31] offset0:6 offset1:7
    s_mov_b32 exec_lo, 0x55555555
    s_mov_b32 exec_hi, 0
    ds_write_b16 v13, v24 offset:2088
    ds_write_b16 v13, v26 offset:2600
    ds_write_b16 v13, v28 offset:3112
    ds_write_b16 v13, v30 offset:3624
    s_mov_b64 exec, -1
L_kx1:
    s_lshl_b32 s72, s69, 8
    s_add_u32 s72, s72, 3407872
    v_mov_b32 v8, 4
    s_mov_b64 exec, 1
    ds_write_b32 v3, v8 offset:31792
    s_mov_b64 exec, -1
    v_lshlrev_b32 v7, 2, v0
    s_mov_b32 s79, 400000
L_lw24:
    ds_read_b32 v8, v2 offset:31792
    s_waitcnt lgkmcnt(0)
    v_cmp_gt_u32 vcc, 4, v8
    s_sub_u32 s79, s79, 1
    s_cbranch_scc1 L_lwd24
    s_cbranch_vccz L_lwd24
    s_sleep 1
    s_branch L_lw24
L_lwd24:
    s_mov_b32 s79, 400000
L_lw25:
    ds_read_b32 v8, v2 offset:31824
    s_waitcnt lgkmcnt(0)
    v_cmp_gt_u32 vcc, 1, v8
    s_sub_u32 s79, s79, 1
    s_cbranch_scc1 L_lwd25
    s_cbranch_vccz L_lwd25
    s_sleep 1
    s_branch L_lw25
L_lwd25:
    s_cmp_lg_u32 s67, 0
    s_cbranch_scc1 L_convB
    ds_read_b64_tr_b16 v[16:17], v4 offset:0
    ds_read_b64_tr_b16 v[18:19], v4 offset:32
    ds_read_b64_tr_b16 v[20:21], v4 offset:256
    ds_read_b64_tr_b16 v[22:23], v4 offset:288
    ds_read_b64_tr_b16 v[24:25], v4 offset:512
    ds_read_b64_tr_b16 v[26:27], v4 offset:544
    ds_read_b64_tr_b16 v[28:29], v4 offset:768
    ds_read_b64_tr_b16 v[30:31], v4 offset:800
    ds_read_b64_tr_b16 v[32:33], v4 offset:1024
    ds_read_b64_tr_b16 v[34:35], v4 offset:1056
    ds_read_b64_tr_b16 v[36:37], v4 offset:1280
    ds_read_b64_tr_b16 v[38:39], v4 offset:1312
    ds_read_b64_tr_b16 v[40:41], v4 offset:1536
    ds_read_b64_tr_b16 v[42:43], v4 offset:1568
    ds_read_b64_tr_b16 v[44:45], v4 offset:1792
    ds_read_b64_tr_b16 v[46:47], v4 offset:1824
    ds_read_b64_tr_b16 v[48:49], v4 offset:2048
    ds_read_b64_tr_b16 v[50:51], v4 offset:2080
    ds_read_b64_tr_b16 v[52:53], v4 offset:2304
    ds_read_b64_tr_b16 v[54:55], v4 offset:2336
    ds_read_b64_tr_b16 v[56:57], v4 offset:2560
    ds_read_b64_tr_b16 v[58:59], v4 offset:2592
    ds_read_b64_tr_b16 v[148:149], v5 offset:17472
    ds_read_b64_tr_b16 v[150:151], v5 offset:17408
    ds_read_b64_tr_b16 v[152:153], v5 offset:17728
    ds_read_b64_tr_b16 v[154:155], v5 offset:17664
    ds_read_b64_tr_b16 v[156:157], v5 offset:17984
    ds_read_b64_tr_b16 v[158:159], v5 offset:17920
    ds_read_b64_tr_b16 v[160:161], v5 offset:18240
    ds_read_b64_tr_b16 v[162:163], v5 offset:18176
    s_mov_b32 s79, 400000
L_lw26:
    ds_read_b32 v8, v3 offset:31808
    s_waitcnt lgkmcnt(0)
    v_cmp_gt_u32 vcc, 1, v8
    s_sub_u32 s79, s79, 1
    s_cbranch_scc1 L_lwd26
    s_cbranch_vccz L_lwd26
    s_sleep 1
    s_branch L_lw26
L_lwd26:
    s_setprio 2
    ds_read_b64_tr_b16 v[164:165], v5 offset:18496
    ds_read_b64_tr_b16 v[166:167], v5 offset:18432
    v_mfma_f32_16x16x32_bf16 v[60:63], v[148:151], v[16:19], 0
    v_mfma_f32_16x16x32_bf16 v[68:71], v[148:151], v[20:23], 0
    v_mfma_f32_16x16x32_bf16 v[76:79], v[148:151], v[24:27], 0
    v_mfma_f32_16x16x32_bf16 v[84:87], v[148:151], v[28:31], 0
    v_mfma_f32_16x16x32_bf16 v[92:95], v[148:151], v[32:35], 0
    v_mfma_f32_16x16x32_bf16 v[100:103], v[148:151], v[36:39], 0
    v_mfma_f32_16x16x32_bf16 v[108:111], v[148:151], v[40:43], 0
    v_mfma_f32_16x16x32_bf16 v[116:119], v[148:151], v[44:47], 0
    s_nop 0
    v_add_f32_dpp v14, v63, v62 wave_shr:1 row_mask:0xf bank_mask:0xf bound_ctrl:0
    v_mfma_f32_16x16x32_bf16 v[124:127], v[148:151], v[48:51], 0
    s_nop 0
    v_add_f32_dpp v12, v14, v61 wave_shr:1 row_mask:0xf bank_mask:0xf bound_ctrl:0
    v_mfma_f32_16x16x32_bf16 v[132:135], v[148:151], v[52:55], 0
    s_nop 0
    v_add_f32_dpp v10, v12, v60 wave_shr:1 row_mask:0xf bank_mask:0xf bound_ctrl:0
    v_mfma_f32_16x16x32_bf16 v[140:143], v[148:151], v[56:59], 0
    ds_read_b64_tr_b16 v[148:149], v5 offset:18752
    ds_read_b64_tr_b16 v[150:151], v5 offset:18688
    v_mfma_f32_16x16x32_bf16 v[64:67], v[152:155], v[16:19], 0
    v_mfma_f32_16x16x32_bf16 v[72:75], v[152:155], v[20:23], 0
    v_mfma_f32_16x16x32_bf16 v[80:83], v[152:155], v[24:27], 0
    v_mfma_f32_16x16x32_bf16 v[88:91], v[152:155], v[28:31], 0
    v_mfma_f32_16x16x32_bf16 v[96:99], v[152:155], v[32:35], 0
    v_mfma_f32_16x16x32_bf16 v[104:107], v[152:155], v[36:39], 0
    v_mfma_f32_16x16x32_bf16 v[112:115], v[152:155], v[40:43], 0
    v_mfma_f32_16x16x32_bf16 v[120:123], v[152:155], v[44:47], 0
    s_nop 0
    v_add_f32_dpp v15, v63, v66 wave_ror:1 row_mask:0xf bank_mask:0xf
    v_add_f32_dpp v13, v14, v65 wave_ror:1 row_mask:0xf bank_mask:0xf
    v_mfma_f32_16x16x32_bf16 v[128:131], v[152:155], v[48:51], 0
    v_add_f32_dpp v11, v12, v64 wave_ror:1 row_mask:0xf bank_mask:0xf
    v_add_f32_dpp v15, v67, v66 wave_shr:1 row_mask:0xf bank_mask:0xf
    v_mfma_f32_16x16x32_bf16 v[136:139], v[152:155], v[52:55], 0
    v_mfma_f32_16x16x32_bf16 v[144:147], v[152:155], v[56:59], 0
    v_add_f32_dpp v13, v15, v65 wave_shr:1 row_mask:0xf bank_mask:0xf
    ds_read_b64_tr_b16 v[152:153], v5 offset:19008
    ds_read_b64_tr_b16 v[154:155], v5 offset:18944
    v_mfma_f32_16x16x32_bf16 v[68:71], v[156:159], v[16:19], v[68:71]
    v_add_f32_dpp v11, v13, v64 wave_shr:1 row_mask:0xf bank_mask:0xf
    v_cvt_pk_bf16_f32 v64, v10, v11
    v_mfma_f32_16x16x32_bf16 v[76:79], v[156:159], v[20:23], v[76:79]
    s_add_u32 s64, s72, 0
    buffer_store_dword v64, v7, s[44:47], s64 offen sc1
    v_mfma_f32_16x16x32_bf16 v[84:87], v[156:159], v[24:27], v[84:87]
    v_mfma_f32_16x16x32_bf16 v[92:95], v[156:159], v[28:31], v[92:95]
    s_nop 0
    v_add_f32_dpp v14, v67, v70 wave_ror:1 row_mask:0xf bank_mask:0xf
    v_add_f32_dpp v12, v15, v69 wave_ror:1 row_mask:0xf bank_mask:0xf
    v_mfma_f32_16x16x32_bf16 v[100:103], v[156:159], v[32:35], v[100:103]
    v_add_f32_dpp v10, v13, v68 wave_ror:1 row_mask:0xf bank_mask:0xf
    v_add_f32_dpp v14, v71, v70 wave_shr:1 row_mask:0xf bank_mask:0xf
    v_mfma_f32_16x16x32_bf16 v[108:111], v[156:159], v[36:39], v[108:111]
    v_mfma_f32_16x16x32_bf16 v[116:119], v[156:159], v[40:43], v[116:119]
    v_add_f32_dpp v12, v14, v69 wave_shr:1 row_mask:0xf bank_mask:0xf
    v_mfma_f32_16x16x32_bf16 v[124:127], v[156:159], v[44:47], v[124:127]
    s_nop 0
    v_add_f32_dpp v10, v12, v68 wave_shr:1 row_mask:0xf bank_mask:0xf
    v_mfma_f32_16x16x32_bf16 v[132:135], v[156:159], v[48:51], v[132:135]
    v_mfma_f32_16x16x32_bf16 v[140:143], v[156:159], v[52:55], v[140:143]
    ds_read_b64_tr_b16 v[156:157], v5 offset:19264
    ds_read_b64_tr_b16 v[158:159], v5 offset:19200
    v_mfma_f32_16x16x32_bf16 v[72:75], v[160:163], v[16:19], v[72:75]
    v_mfma_f32_16x16x32_bf16 v[80:83], v[160:163], v[20:23], v[80:83]
    v_mfma_f32_16x16x32_bf16 v[88:91], v[160:163], v[24:27], v[88:91]
    v_mfma_f32_16x16x32_bf16 v[96:99], v[160:163], v[28:31], v[96:99]
    v_mfma_f32_16x16x32_bf16 v[104:107], v[160:163], v[32:35], v[104:107]
    v_mfma_f32_16x16x32_bf16 v[112:115], v[160:163], v[36:39], v[112:115]
    v_mfma_f32_16x16x32_bf16 v[120:123], v[160:163], v[40:43], v[120:123]
    v_mfma_f32_16x16x32_bf16 v[128:131], v[160:163], v[44:47], v[128:131]
    s_nop 0
    v_add_f32_dpp v15, v71, v74 wave_ror:1 row_mask:0xf bank_mask:0xf
    v_add_f32_dpp v13, v14, v73 wave_ror:1 row_mask:0xf bank_mask:0xf
    v_mfma_f32_16x16x32_bf16 v[136:139], v[160:163], v[48:51], v[136:139]
    v_add_f32_dpp v11, v12, v72 wave_ror:1 row_mask:0xf bank_mask:0xf
    v_add_f32_dpp v15, v75, v74 wave_shr:1 row_mask:0xf bank_mask:0xf
    v_mfma_f32_16x16x32_bf16 v[144:147], v[160:163], v[52:55], v[144:147]
    ds_read_b64_tr_b16 v[160:161], v5 offset:19520
    ds_read_b64_tr_b16 v[162:163], v5 offset:19456
    s_waitcnt lgkmcnt(8)
    v_mfma_f32_16x16x32_bf16 v[76:79], v[164:167], v[16:19], v[76:79]
    v_add_f32_dpp v13, v15, v73 wave_shr:1 row_mask:0xf bank_mask:0xf
    v_mfma_f32_16x16x32_bf16 v[84:87], v[164:167], v[20:23], v[84:87]
    s_nop 0
    v_add_f32_dpp v11, v13, v72 wave_shr:1 row_mask:0xf bank_mask:0xf
    v_cvt_pk_bf16_f32 v72, v10, v11
    v_mfma_f32_16x16x32_bf16 v[92:95], v[164:167], v[24:27], v[92:95]
    s_add_u32 s64, s72, 131328
    buffer_store_dword v72, v7, s[44:47], s64 offen sc1
    v_mfma_f32_16x16x32_bf16 v[100:103], v[164:167], v[28:31], v[100:103]
    v_add_f32_dpp v14, v75, v78 wave_ror:1 row_mask:0xf bank_mask:0xf
    v_add_f32_dpp v12, v15, v77 wave_ror:1 row_mask:0xf bank_mask:0xf
    v_mfma_f32_16x16x32_bf16 v[108:111], v[164:167], v[32:35], v[108:111]
    v_add_f32_dpp v10, v13, v76 wave_ror:1 row_mask:0xf bank_mask:0xf
    v_add_f32_dpp v14, v79, v78 wave_shr:1 row_mask:0xf bank_mask:0xf
    v_mfma_f32_16x16x32_bf16 v[116:119], v[164:167], v[36:39], v[116:119]
    v_mfma_f32_16x16x32_bf16 v[124:127], v[164:167], v[40:43], v[124:127]
    v_add_f32_dpp v12, v14, v77 wave_shr:1 row_mask:0xf bank_mask:0xf
    v_mfma_f32_16x16x32_bf16 v[132:135], v[164:167], v[44:47], v[132:135]
    s_nop 0
    v_add_f32_dpp v10, v12, v76 wave_shr:1 row_mask:0xf bank_mask:0xf
    v_mfma_f32_16x16x32_bf16 v[140:143], v[164:167], v[48:51], v[140:143]
    ds_read_b64_tr_b16 v[164:165], v5 offset:19776
    ds_read_b64_tr_b16 v[166:167], v5 offset:19712
    ds_read_b64_tr_b16 v[60:61], v5 offset:20032
    ds_read_b64_tr_b16 v[62:63], v5 offset:19968
    s_waitcnt lgkmcnt(10)
    v_mfma_f32_16x16x32_bf16 v[80:83], v[148:151], v[16:19], v[80:83]
    v_mfma_f32_16x16x32_bf16 v[88:91], v[148:151], v[20:23], v[88:91]
    v_mfma_f32_16x16x32_bf16 v[96:99], v[148:151], v[24:27], v[96:99]
    v_mfma_f32_16x16x32_bf16 v[104:107], v[148:151], v[28:31], v[104:107]
    v_mfma_f32_16x16x32_bf16 v[112:115], v[148:151], v[32:35], v[112:115]
    v_mfma_f32_16x16x32_bf16 v[120:123], v[148:151], v[36:39], v[120:123]
    v_mfma_f32_16x16x32_bf16 v[128:131], v[148:151], v[40:43], v[128:131]
    v_mfma_f32_16x16x32_bf16 v[136:139], v[148:151], v[44:47], v[136:139]
    s_nop 0
    v_add_f32_dpp v15, v79, v82 wave_ror:1 row_mask:0xf bank_mask:0xf
    v_add_f32_dpp v13, v14, v81 wave_ror:1 row_mask:0xf bank_mask:0xf
    v_mfma_f32_16x16x32_bf16 v[144:147], v[148:151], v[48:51], v[144:147]
    v_add_f32_dpp v11, v12, v80 wave_ror:1 row_mask:0xf bank_mask:0xf
    v_add_f32_dpp v15, v83, v82 wave_shr:1 row_mask:0xf bank_mask:0xf
    ds_read_b64_tr_b16 v[68:69], v5 offset:20288
    ds_read_b64_tr_b16 v[70:71], v5 offset:20224
    s_waitcnt lgkmcnt(10)
    v_mfma_f32_16x16x32_bf16 v[84:87], v[152:155], v[16:19], v[84:87]
    v_mfma_f32_16x16x32_bf16 v[92:95], v[152:155], v[20:23], v[92:95]
    v_add_f32_dpp v13, v15, v81 wave_shr:1 row_mask:0xf bank_mask:0xf
    v_mfma_f32_16x16x32_bf16 v[100:103], v[152:155], v[24:27], v[100:103]
    s_nop 0
    v_add_f32_dpp v11, v13, v80 wave_shr:1 row_mask:0xf bank_mask:0xf
    v_cvt_pk_bf16_f32 v80, v10, v11
    v_mfma_f32_16x16x32_bf16 v[108:111], v[152:155], v[28:31], v[108:111]
    s_add_u32 s64, s72, 262656
    buffer_store_dword v80, v7, s[44:47], s64 offen sc1
    v_add_f32_dpp v14, v83, v86 wave_ror:1 row_mask:0xf bank_mask:0xf
    v_add_f32_dpp v12, v15, v85 wave_ror:1 row_mask:0xf bank_mask:0xf
    v_mfma_f32_16x16x32_bf16 v[116:119], v[152:155], v[32:35], v[116:119]
    v_add_f32_dpp v10, v13, v84 wave_ror:1 row_mask:0xf bank_mask:0xf
    v_add_f32_dpp v14, v87, v86 wave_shr:1 row_mask:0xf bank_mask:0xf
    v_mfma_f32_16x16x32_bf16 v[124:127], v[152:155], v[36:39], v[124:127]
    v_mfma_f32_16x16x32_bf16 v[132:135], v[152:155], v[40:43], v[132:135]
    v_add_f32_dpp v12, v14, v85 wave_shr:1 row_mask:0xf bank_mask:0xf
    v_mfma_f32_16x16x32_bf16 v[140:143], v[152:155], v[44:47], v[140:143]
    s_nop 0
    v_add_f32_dpp v10, v12, v84 wave_shr:1 row_mask:0xf bank_mask:0xf
    s_waitcnt lgkmcnt(8)
    v_mfma_f32_16x16x32_bf16 v[88:91], v[156:159], v[16:19], v[88:91]
    v_mfma_f32_16x16x32_bf16 v[96:99], v[156:159], v[20:23], v[96:99]
    v_mfma_f32_16x16x32_bf16 v[104:107], v[156:159], v[24:27], v[104:107]
    v_mfma_f32_16x16x32_bf16 v[112:115], v[156:159], v[28:31], v[112:115]
    v_mfma_f32_16x16x32_bf16 v[120:123], v[156:159], v[32:35], v[120:123]
    v_mfma_f32_16x16x32_bf16 v[128:131], v[156:159], v[36:39], v[128:131]
    v_mfma_f32_16x16x32_bf16 v[136:139], v[156:159], v[40:43], v[136:139]
    v_mfma_f32_16x16x32_bf16 v[144:147], v[156:159], v[44:47], v[144:147]
    s_nop 0
    v_add_f32_dpp v15, v87, v90 wave_ror:1 row_mask:0xf bank_mask:0xf
    v_add_f32_dpp v13, v14, v89 wave_ror:1 row_mask:0xf bank_mask:0xf
    ds_read_b64_tr_b16 v[76:77], v5 offset:20544
    ds_read_b64_tr_b16 v[78:79], v5 offset:20480
    s_waitcnt lgkmcnt(8)
    v_mfma_f32_16x16x32_bf16 v[92:95], v[160:163], v[16:19], v[92:95]
    v_add_f32_dpp v11, v12, v88 wave_ror:1 row_mask:0xf bank_mask:0xf
    v_add_f32_dpp v15, v91, v90 wave_shr:1 row_mask:0xf bank_mask:0xf
    v_mfma_f32_16x16x32_bf16 v[100:103], v[160:163], v[20:23], v[100:103]
    v_mfma_f32_16x16x32_bf16 v[108:111], v[160:163], v[24:27], v[108:111]
    v_add_f32_dpp v13, v15, v89 wave_shr:1 row_mask:0xf bank_mask:0xf
    v_mfma_f32_16x16x32_bf16 v[116:119], v[160:163], v[28:31], v[116:119]
    s_nop 0
    v_add_f32_dpp v11, v13, v88 wave_shr:1 row_mask:0xf bank_mask:0xf
    v_cvt_pk_bf16_f32 v88, v10, v11
    v_mfma_f32_16x16x32_bf16 v[124:127], v[160:163], v[32:35], v[124:127]
    s_add_u32 s64, s72, 393984
    buffer_store_dword v88, v7, s[44:47], s64 offen sc1
    v_add_f32_dpp v14, v91, v94 wave_ror:1 row_mask:0xf bank_mask:0xf
    v_add_f32_dpp v12, v15, v93 wave_ror:1 row_mask:0xf bank_mask:0xf
    v_mfma_f32_16x16x32_bf16 v[132:135], v[160:163], v[36:39], v[132:135]
    v_add_f32_dpp v10, v13, v92 wave_ror:1 row_mask:0xf bank_mask:0xf
    v_add_f32_dpp v14, v95, v94 wave_shr:1 row_mask:0xf bank_mask:0xf
    v_mfma_f32_16x16x32_bf16 v[140:143], v[160:163], v[40:43], v[140:143]
    s_waitcnt lgkmcnt(6)
    v_mfma_f32_16x16x32_bf16 v[96:99], v[164:167], v[16:19], v[96:99]
    v_add_f32_dpp v12, v14, v93 wave_shr:1 row_mask:0xf bank_mask:0xf
    v_mfma_f32_16x16x32_bf16 v[104:107], v[164:167], v[20:23], v[104:107]
    s_nop 0
    v_add_f32_dpp v10, v12, v92 wave_shr:1 row_mask:0xf bank_mask:0xf
    v_mfma_f32_16x16x32_bf16 v[112:115], v[164:167], v[24:27], v[112:115]
    v_mfma_f32_16x16x32_bf16 v[120:123], v[164:167], v[28:31], v[120:123]
    s_nop 1
    v_add_f32_dpp v15, v95, v98 wave_ror:1 row_mask:0xf bank_mask:0xf
    v_add_f32_dpp v13, v14, v97 wave_ror:1 row_mask:0xf bank_mask:0xf
    v_mfma_f32_16x16x32_bf16 v[128:131], v[164:167], v[32:35], v[128:131]
    v_add_f32_dpp v11, v12, v96 wave_ror:1 row_mask:0xf bank_mask:0xf
    v_add_f32_dpp v15, v99, v98 wave_shr:1 row_mask:0xf bank_mask:0xf
    v_mfma_f32_16x16x32_bf16 v[136:139], v[164:167], v[36:39], v[136:139]
    v_mfma_f32_16x16x32_bf16 v[144:147], v[164:167], v[40:43], v[144:147]
    v_add_f32_dpp v13, v15, v97 wave_shr:1 row_mask:0xf bank_mask:0xf
    ds_read_b64_tr_b16 v[84:85], v5 offset:20800
    ds_read_b64_tr_b16 v[86:87], v5 offset:20736
    s_waitcnt lgkmcnt(6)
    v_mfma_f32_16x16x32_bf16 v[100:103], v[60:63], v[16:19], v[100:103]
    v_add_f32_dpp v11, v13, v96 wave_shr:1 row_mask:0xf bank_mask:0xf
    v_cvt_pk_bf16_f32 v96, v10, v11
    v_mfma_f32_16x16x32_bf16 v[108:111], v[60:63], v[20:23], v[108:111]
    s_add_u32 s64, s72, 525312
    buffer_store_dword v96, v7, s[44:47], s64 offen sc1
    v_mfma_f32_16x16x32_bf16 v[116:119], v[60:63], v[24:27], v[116:119]
    v_mfma_f32_16x16x32_bf16 v[124:127], v[60:63], v[28:31], v[124:127]
    s_nop 0
    v_add_f32_dpp v14, v99, v102 wave_ror:1 row_mask:0xf bank_mask:0xf
    v_add_f32_dpp v12, v15, v101 wave_ror:1 row_mask:0xf bank_mask:0xf
    v_mfma_f32_16x16x32_bf16 v[132:135], v[60:63], v[32:35], v[132:135]
    v_add_f32_dpp v10, v13, v100 wave_ror:1 row_mask:0xf bank_mask:0xf
    v_add_f32_dpp v14, v103, v102 wave_shr:1 row_mask:0xf bank_mask:0xf
    v_mfma_f32_16x16x32_bf16 v[140:143], v[60:63], v[36:39], v[140:143]
    ds_read_b64_tr_b16 v[60:61], v5 offset:21568
    ds_read_b64_tr_b16 v[62:63], v5 offset:21504
    s_waitcnt lgkmcnt(6)
    v_mfma_f32_16x16x32_bf16 v[104:107], v[68:71], v[16:19], v[104:107]
    v_add_f32_dpp v12, v14, v101 wave_shr:1 row_mask:0xf bank_mask:0xf
    v_mfma_f32_16x16x32_bf16 v[112:115], v[68:71], v[20:23], v[112:115]
    s_nop 0
    v_add_f32_dpp v10, v12, v100 wave_shr:1 row_mask:0xf bank_mask:0xf
    v_mfma_f32_16x16x32_bf16 v[120:123], v[68:71], v[24:27], v[120:123]
    v_mfma_f32_16x16x32_bf16 v[128:131], v[68:71], v[28:31], v[128:131]
    s_nop 1
    v_add_f32_dpp v15, v103, v106 wave_ror:1 row_mask:0xf bank_mask:0xf
    v_add_f32_dpp v13, v14, v105 wave_ror:1 row_mask:0xf bank_mask:0xf
    v_mfma_f32_16x16x32_bf16 v[136:139], v[68:71], v[32:35], v[136:139]
    v_add_f32_dpp v11, v12, v104 wave_ror:1 row_mask:0xf bank_mask:0xf
    v_add_f32_dpp v15, v107, v106 wave_shr:1 row_mask:0xf bank_mask:0xf
    v_mfma_f32_16x16x32_bf16 v[144:147], v[68:71], v[36:39], v[144:147]
    ds_read_b64_tr_b16 v[92:93], v5 offset:21056
    ds_read_b64_tr_b16 v[94:95], v5 offset:20992
    ds_read_b64_tr_b16 v[68:69], v5 offset:21824
    ds_read_b64_tr_b16 v[70:71], v5 offset:21760
    s_waitcnt lgkmcnt(8)
    v_mfma_f32_16x16x32_bf16 v[108:111], v[76:79], v[16:19], v[108:111]
    v_add_f32_dpp v13, v15, v105 wave_shr:1 row_mask:0xf bank_mask:0xf
    v_mfma_f32_16x16x32_bf16 v[116:119], v[76:79], v[20:23], v[116:119]
    s_nop 0
    v_add_f32_dpp v11, v13, v104 wave_shr:1 row_mask:0xf bank_mask:0xf
    v_cvt_pk_bf16_f32 v104, v10, v11
    v_mfma_f32_16x16x32_bf16 v[124:127], v[76:79], v[24:27], v[124:127]
    s_add_u32 s64, s72, 656640
    buffer_store_dword v104, v7, s[44:47], s64 offen sc1
    v_mfma_f32_16x16x32_bf16 v[132:135], v[76:79], v[28:31], v[132:135]
    v_add_f32_dpp v14, v107, v110 wave_ror:1 row_mask:0xf bank_mask:0xf
    v_add_f32_dpp v12, v15, v109 wave_ror:1 row_mask:0xf bank_mask:0xf
    v_mfma_f32_16x16x32_bf16 v[140:143], v[76:79], v[32:35], v[140:143]
    v_add_f32_dpp v10, v13, v108 wave_ror:1 row_mask:0xf bank_mask:0xf
    v_add_f32_dpp v14, v111, v110 wave_shr:1 row_mask:0xf bank_mask:0xf
    ds_read_b64_tr_b16 v[76:77], v5 offset:22080
    ds_read_b64_tr_b16 v[78:79], v5 offset:22016
    s_waitcnt lgkmcnt(8)
    v_mfma_f32_16x16x32_bf16 v[112:115], v[84:87], v[16:19], v[112:115]
    v_mfma_f32_16x16x32_bf16 v[120:123], v[84:87], v[20:23], v[120:123]
    v_add_f32_dpp v12, v14, v109 wave_shr:1 row_mask:0xf bank_mask:0xf
    v_mfma_f32_16x16x32_bf16 v[128:131], v[84:87], v[24:27], v[128:131]
    s_nop 0
    v_add_f32_dpp v10, v12, v108 wave_shr:1 row_mask:0xf bank_mask:0xf
    v_mfma_f32_16x16x32_bf16 v[136:139], v[84:87], v[28:31], v[136:139]
    s_nop 1
    v_add_f32_dpp v15, v111, v114 wave_ror:1 row_mask:0xf bank_mask:0xf
    v_add_f32_dpp v13, v14, v113 wave_ror:1 row_mask:0xf bank_mask:0xf
    v_mfma_f32_16x16x32_bf16 v[144:147], v[84:87], v[32:35], v[144:147]
    v_add_f32_dpp v11, v12, v112 wave_ror:1 row_mask:0xf bank_mask:0xf
    v_add_f32_dpp v15, v115, v114 wave_shr:1 row_mask:0xf bank_mask:0xf
    ds_read_b64_tr_b16 v[100:101], v5 offset:21312
    ds_read_b64_tr_b16 v[102:103], v5 offset:21248
    ds_read_b64_tr_b16 v[84:85], v5 offset:22336
    ds_read_b64_tr_b16 v[86:87], v5 offset:22272
    s_waitcnt lgkmcnt(8)
    v_mfma_f32_16x16x32_bf16 v[116:119], v[92:95], v[16:19], v[116:119]
    v_mfma_f32_16x16x32_bf16 v[124:127], v[92:95], v[20:23], v[124:127]
    v_add_f32_dpp v13, v15, v113 wave_shr:1 row_mask:0xf bank_mask:0xf
    v_mfma_f32_16x16x32_bf16 v[132:135], v[92:95], v[24:27], v[132:135]
    s_nop 0
    v_add_f32_dpp v11, v13, v112 wave_shr:1 row_mask:0xf bank_mask:0xf
    v_cvt_pk_bf16_f32 v112, v10, v11
    v_mfma_f32_16x16x32_bf16 v[140:143], v[92:95], v[28:31], v[140:143]
    s_add_u32 s64, s72, 787968
    buffer_store_dword v112, v7, s[44:47], s64 offen sc1
    v_add_f32_dpp v14, v115, v118 wave_ror:1 row_mask:0xf bank_mask:0xf
    v_add_f32_dpp v12, v15, v117 wave_ror:1 row_mask:0xf bank_mask:0xf
    ds_read_b64_tr_b16 v[92:93], v5 offset:22592
    ds_read_b64_tr_b16 v[94:95], v5 offset:22528
    s_waitcnt lgkmcnt(4)
    v_mfma_f32_16x16x32_bf16 v[120:123], v[100:103], v[16:19], v[120:123]
    v_add_f32_dpp v10, v13, v116 wave_ror:1 row_mask:0xf bank_mask:0xf
    v_add_f32_dpp v14, v119, v118 wave_shr:1 row_mask:0xf bank_mask:0xf
    v_mfma_f32_16x16x32_bf16 v[128:131], v[100:103], v[20:23], v[128:131]
    v_mfma_f32_16x16x32_bf16 v[136:139], v[100:103], v[24:27], v[136:139]
    v_add_f32_dpp v12, v14, v117 wave_shr:1 row_mask:0xf bank_mask:0xf
    v_mfma_f32_16x16x32_bf16 v[144:147], v[100:103], v[28:31], v[144:147]
    s_nop 0
    v_add_f32_dpp v10, v12, v116 wave_shr:1 row_mask:0xf bank_mask:0xf
    v_add_f32_dpp v15, v119, v122 wave_ror:1 row_mask:0xf bank_mask:0xf
    ds_read_b64_tr_b16 v[100:101], v5 offset:22848
    ds_read_b64_tr_b16 v[102:103], v5 offset:22784
    v_mfma_f32_16x16x32_bf16 v[124:127], v[60:63], v[16:19], v[124:127]
    v_add_f32_dpp v13, v14, v121 wave_ror:1 row_mask:0xf bank_mask:0xf
    v_add_f32_dpp v11, v12, v120 wave_ror:1 row_mask:0xf bank_mask:0xf
    v_mfma_f32_16x16x32_bf16 v[132:135], v[60:63], v[20:23], v[132:135]
    v_add_f32_dpp v15, v123, v122 wave_shr:1 row_mask:0xf bank_mask:0xf
    v_mfma_f32_16x16x32_bf16 v[140:143], v[60:63], v[24:27], v[140:143]
    s_nop 0
    v_add_f32_dpp v13, v15, v121 wave_shr:1 row_mask:0xf bank_mask:0xf
    v_mfma_f32_16x16x32_bf16 v[128:131], v[68:71], v[16:19], v[128:131]
    s_nop 0
    v_add_f32_dpp v11, v13, v120 wave_shr:1 row_mask:0xf bank_mask:0xf
    v_cvt_pk_bf16_f32 v120, v10, v11
    v_mfma_f32_16x16x32_bf16 v[136:139], v[68:71], v[20:23], v[136:139]
    s_add_u32 s64, s72, 919296
    buffer_store_dword v120, v7, s[44:47], s64 offen sc1
    v_add_f32_dpp v14, v123, v126 wave_ror:1 row_mask:0xf bank_mask:0xf
    v_add_f32_dpp v12, v15, v125 wave_ror:1 row_mask:0xf bank_mask:0xf
    v_mfma_f32_16x16x32_bf16 v[144:147], v[68:71], v[24:27], v[144:147]
    v_add_f32_dpp v10, v13, v124 wave_ror:1 row_mask:0xf bank_mask:0xf
    v_add_f32_dpp v14, v127, v126 wave_shr:1 row_mask:0xf bank_mask:0xf
    v_mfma_f32_16x16x32_bf16 v[132:135], v[76:79], v[16:19], v[132:135]
    v_mfma_f32_16x16x32_bf16 v[140:143], v[76:79], v[20:23], v[140:143]
    v_add_f32_dpp v12, v14, v125 wave_shr:1 row_mask:0xf bank_mask:0xf
    s_waitcnt lgkmcnt(4)
    v_mfma_f32_16x16x32_bf16 v[136:139], v[84:87], v[16:19], v[136:139]
    v_add_f32_dpp v10, v12, v124 wave_shr:1 row_mask:0xf bank_mask:0xf
    v_add_f32_dpp v15, v127, v130 wave_ror:1 row_mask:0xf bank_mask:0xf
    v_mfma_f32_16x16x32_bf16 v[144:147], v[84:87], v[20:23], v[144:147]
    v_add_f32_dpp v13, v14, v129 wave_ror:1 row_mask:0xf bank_mask:0xf
    v_add_f32_dpp v11, v12, v128 wave_ror:1 row_mask:0xf bank_mask:0xf
    s_waitcnt lgkmcnt(2)
    v_mfma_f32_16x16x32_bf16 v[140:143], v[92:95], v[16:19], v[140:143]
    v_add_f32_dpp v15, v131, v130 wave_shr:1 row_mask:0xf bank_mask:0xf
    s_waitcnt lgkmcnt(0)
    v_mfma_f32_16x16x32_bf16 v[144:147], v[100:103], v[16:19], v[144:147]
    v_add_f32_dpp v13, v15, v129 wave_shr:1 row_mask:0xf bank_mask:0xf
    s_nop 1
    v_add_f32_dpp v11, v13, v128 wave_shr:1 row_mask:0xf bank_mask:0xf
    v_cvt_pk_bf16_f32 v128, v10, v11
    s_add_u32 s64, s72, 1050624
    buffer_store_dword v128, v7, s[44:47], s64 offen sc1
    v_add_f32_dpp v14, v131, v134 wave_ror:1 row_mask:0xf bank_mask:0xf
    v_add_f32_dpp v12, v15, v133 wave_ror:1 row_mask:0xf bank_mask:0xf
    v_add_f32_dpp v10, v13, v132 wave_ror:1 row_mask:0xf bank_mask:0xf
    v_add_f32_dpp v14, v135, v134 wave_shr:1 row_mask:0xf bank_mask:0xf
    s_nop 1
    v_add_f32_dpp v12, v14, v133 wave_shr:1 row_mask:0xf bank_mask:0xf
    s_nop 1
    v_add_f32_dpp v10, v12, v132 wave_shr:1 row_mask:0xf bank_mask:0xf
    v_add_f32_dpp v15, v135, v138 wave_ror:1 row_mask:0xf bank_mask:0xf
    v_add_f32_dpp v13, v14, v137 wave_ror:1 row_mask:0xf bank_mask:0xf
    v_add_f32_dpp v11, v12, v136 wave_ror:1 row_mask:0xf bank_mask:0xf
    v_add_f32_dpp v15, v139, v138 wave_shr:1 row_mask:0xf bank_mask:0xf
    s_nop 1
    v_add_f32_dpp v13, v15, v137 wave_shr:1 row_mask:0xf bank_mask:0xf
    s_nop 1
    v_add_f32_dpp v11, v13, v136 wave_shr:1 row_mask:0xf bank_mask:0xf
    v_cvt_pk_bf16_f32 v136, v10, v11
    s_add_u32 s64, s72, 1181952
    buffer_store_dword v136, v7, s[44:47], s64 offen sc1
    v_add_f32_dpp v14, v139, v142 wave_ror:1 row_mask:0xf bank_mask:0xf
    v_add_f32_dpp v12, v15, v141 wave_ror:1 row_mask:0xf bank_mask:0xf
    v_add_f32_dpp v10, v13, v140 wave_ror:1 row_mask:0xf bank_mask:0xf
    v_add_f32_dpp v14, v143, v142 wave_shr:1 row_mask:0xf bank_mask:0xf
    s_nop 1
    v_add_f32_dpp v12, v14, v141 wave_shr:1 row_mask:0xf bank_mask:0xf
    s_nop 1
    v_add_f32_dpp v10, v12, v140 wave_shr:1 row_mask:0xf bank_mask:0xf
    v_add_f32_dpp v15, v143, v146 wave_ror:1 row_mask:0xf bank_mask:0xf
    v_add_f32_dpp v13, v14, v145 wave_ror:1 row_mask:0xf bank_mask:0xf
    v_add_f32_dpp v11, v12, v144 wave_ror:1 row_mask:0xf bank_mask:0xf
    v_add_f32_dpp v15, v147, v146 wave_shr:1 row_mask:0xf bank_mask:0xf
    s_nop 1
    v_add_f32_dpp v13, v15, v145 wave_shr:1 row_mask:0xf bank_mask:0xf
    s_nop 1
    v_add_f32_dpp v11, v13, v144 wave_shr:1 row_mask:0xf bank_mask:0xf
    v_cvt_pk_bf16_f32 v144, v10, v11
    s_add_u32 s64, s72, 1313280
    buffer_store_dword v144, v7, s[44:47], s64 offen sc1
    s_branch L_convE
L_convB:
    ds_read_b64_tr_b16 v[16:17], v4 offset:0
    ds_read_b64_tr_b16 v[18:19], v4 offset:32
    ds_read_b64_tr_b16 v[20:21], v4 offset:256
    ds_read_b64_tr_b16 v[22:23], v4 offset:288
    ds_read_b64_tr_b16 v[24:25], v4 offset:512
    ds_read_b64_tr_b16 v[26:27], v4 offset:544
    ds_read_b64_tr_b16 v[28:29], v4 offset:768
    ds_read_b64_tr_b16 v[30:31], v4 offset:800
    ds_read_b64_tr_b16 v[32:33], v4 offset:1024
    ds_read_b64_tr_b16 v[34:35], v4 offset:1056
    ds_read_b64_tr_b16 v[36:37], v4 offset:1280
    ds_read_b64_tr_b16 v[38:39], v4 offset:1312
    ds_read_b64_tr_b16 v[40:41], v4 offset:1536
    ds_read_b64_tr_b16 v[42:43], v4 offset:1568
    ds_read_b64_tr_b16 v[44:45], v4 offset:1792
    ds_read_b64_tr_b16 v[46:47], v4 offset:1824
    ds_read_b64_tr_b16 v[48:49], v4 offset:2048
    ds_read_b64_tr_b16 v[50:51], v4 offset:2080
    ds_read_b64_tr_b16 v[52:53], v4 offset:2304
    ds_read_b64_tr_b16 v[54:55], v4 offset:2336
    ds_read_b64_tr_b16 v[56:57], v4 offset:2560
    ds_read_b64_tr_b16 v[58:59], v4 offset:2592
    ds_read_b64_tr_b16 v[60:61], v4 offset:2816
    ds_read_b64_tr_b16 v[62:63], v4 offset:2848
    ds_read_b64_tr_b16 v[64:65], v4 offset:3072
    ds_read_b64_tr_b16 v[66:67], v4 offset:3104
    ds_read_b64_tr_b16 v[68:69], v4 offset:3328
    ds_read_b64_tr_b16 v[70:71], v4 offset:3360
    ds_read_b64_tr_b16 v[72:73], v4 offset:3584
    ds_read_b64_tr_b16 v[74:75], v4 offset:3616
    ds_read_b64_tr_b16 v[76:77], v4 offset:3840
    ds_read_b64_tr_b16 v[78:79], v4 offset:3872
    ds_read_b64_tr_b16 v[124:125], v5 offset:17472
    ds_read_b64_tr_b16 v[126:127], v5 offset:17408
    ds_read_b64_tr_b16 v[128:129], v5 offset:17728
    ds_read_b64_tr_b16 v[130:131], v5 offset:17664
    ds_read_b64_tr_b16 v[132:133], v5 offset:17984
    ds_read_b64_tr_b16 v[134:135], v5 offset:17920
    ds_read_b64_tr_b16 v[136:137], v5 offset:18240
    ds_read_b64_tr_b16 v[138:139], v5 offset:18176
    ds_read_b64_tr_b16 v[140:141], v5 offset:18496
    ds_read_b64_tr_b16 v[142:143], v5 offset:18432
    ds_read_b64_tr_b16 v[144:145], v5 offset:18752
    ds_read_b64_tr_b16 v[146:147], v5 offset:18688
    ds_read_b64_tr_b16 v[148:149], v5 offset:19008
    ds_read_b64_tr_b16 v[150:151], v5 offset:18944
    ds_read_b64_tr_b16 v[152:153], v5 offset:19264
    ds_read_b64_tr_b16 v[154:155], v5 offset:19200
    s_mov_b32 s79, 400000
L_lw27:
    ds_read_b32 v8, v3 offset:31808
    s_waitcnt lgkmcnt(0)
    v_cmp_gt_u32 vcc, 1, v8
    s_sub_u32 s79, s79, 1
    s_cbranch_scc1 L_lwd27
    s_cbranch_vccz L_lwd27
    s_sleep 1
    s_branch L_lw27
L_lwd27:
    s_setprio 2
    ds_read_b64_tr_b16 v[156:157], v5 offset:19520
    ds_read_b64_tr_b16 v[158:159], v5 offset:19456
    v_mfma_f32_16x16x32_bf16 v[84:87], v[124:127], v[60:63], 0
    v_mfma_f32_16x16x32_bf16 v[92:95], v[124:127], v[64:67], 0
    v_mfma_f32_16x16x32_bf16 v[100:103], v[124:127], v[68:71], 0
    v_mfma_f32_16x16x32_bf16 v[108:111], v[124:127], v[72:75], 0
    v_mfma_f32_16x16x32_bf16 v[116:119], v[124:127], v[76:79], 0
    ds_read_b64_tr_b16 v[160:161], v5 offset:19776
    ds_read_b64_tr_b16 v[162:163], v5 offset:19712
    v_mfma_f32_16x16x32_bf16 v[80:83], v[128:131], v[56:59], 0
    v_mfma_f32_16x16x32_bf16 v[88:91], v[128:131], v[60:63], 0
    v_mfma_f32_16x16x32_bf16 v[96:99], v[128:131], v[64:67], 0
    v_mfma_f32_16x16x32_bf16 v[104:107], v[128:131], v[68:71], 0
    v_mfma_f32_16x16x32_bf16 v[112:115], v[128:131], v[72:75], 0
    v_mfma_f32_16x16x32_bf16 v[120:123], v[128:131], v[76:79], 0
    ds_read_b64_tr_b16 v[124:125], v5 offset:20032
    ds_read_b64_tr_b16 v[126:127], v5 offset:19968
    v_mfma_f32_16x16x32_bf16 v[84:87], v[132:135], v[56:59], v[84:87]
    v_mfma_f32_16x16x32_bf16 v[92:95], v[132:135], v[60:63], v[92:95]
    v_mfma_f32_16x16x32_bf16 v[100:103], v[132:135], v[64:67], v[100:103]
    v_mfma_f32_16x16x32_bf16 v[108:111], v[132:135], v[68:71], v[108:111]
    v_mfma_f32_16x16x32_bf16 v[116:119], v[132:135], v[72:75], v[116:119]
    ds_read_b64_tr_b16 v[128:129], v5 offset:20288
    ds_read_b64_tr_b16 v[130:131], v5 offset:20224
    v_mfma_f32_16x16x32_bf16 v[80:83], v[136:139], v[52:55], v[80:83]
    v_mfma_f32_16x16x32_bf16 v[88:91], v[136:139], v[56:59], v[88:91]
    v_mfma_f32_16x16x32_bf16 v[96:99], v[136:139], v[60:63], v[96:99]
    v_mfma_f32_16x16x32_bf16 v[104:107], v[136:139], v[64:67], v[104:107]
    v_mfma_f32_16x16x32_bf16 v[112:115], v[136:139], v[68:71], v[112:115]
    v_mfma_f32_16x16x32_bf16 v[120:123], v[136:139], v[72:75], v[120:123]
    ds_read_b64_tr_b16 v[132:133], v5 offset:20544
    ds_read_b64_tr_b16 v[134:135], v5 offset:20480
    v_mfma_f32_16x16x32_bf16 v[84:87], v[140:143], v[52:55], v[84:87]
    v_mfma_f32_16x16x32_bf16 v[92:95], v[140:143], v[56:59], v[92:95]
    v_mfma_f32_16x16x32_bf16 v[100:103], v[140:143], v[60:63], v[100:103]
    v_mfma_f32_16x16x32_bf16 v[108:111], v[140:143], v[64:67], v[108:111]
    v_mfma_f32_16x16x32_bf16 v[116:119], v[140:143], v[68:71], v[116:119]
    ds_read_b64_tr_b16 v[136:137], v5 offset:20800
    ds_read_b64_tr_b16 v[138:139], v5 offset:20736
    v_mfma_f32_16x16x32_bf16 v[80:83], v[144:147], v[48:51], v[80:83]
    v_mfma_f32_16x16x32_bf16 v[88:91], v[144:147], v[52:55], v[88:91]
    v_mfma_f32_16x16x32_bf16 v[96:99], v[144:147], v[56:59], v[96:99]
    v_mfma_f32_16x16x32_bf16 v[104:107], v[144:147], v[60:63], v[104:107]
    v_mfma_f32_16x16x32_bf16 v[112:115], v[144:147], v[64:67], v[112:115]
    v_mfma_f32_16x16x32_bf16 v[120:123], v[144:147], v[68:71], v[120:123]
    ds_read_b64_tr_b16 v[140:141], v5 offset:21056
    ds_read_b64_tr_b16 v[142:143], v5 offset:20992
    v_mfma_f32_16x16x32_bf16 v[84:87], v[148:151], v[48:51], v[84:87]
    v_mfma_f32_16x16x32_bf16 v[92:95], v[148:151], v[52:55], v[92:95]
    v_mfma_f32_16x16x32_bf16 v[100:103], v[148:151], v[56:59], v[100:103]
    v_mfma_f32_16x16x32_bf16 v[108:111], v[148:151], v[60:63], v[108:111]
    v_mfma_f32_16x16x32_bf16 v[116:119], v[148:151], v[64:67], v[116:119]
    ds_read_b64_tr_b16 v[144:145], v5 offset:21312
    ds_read_b64_tr_b16 v[146:147], v5 offset:21248
    v_mfma_f32_16x16x32_bf16 v[80:83], v[152:155], v[44:47], v[80:83]
    v_mfma_f32_16x16x32_bf16 v[88:91], v[152:155], v[48:51], v[88:91]
    v_mfma_f32_16x16x32_bf16 v[96:99], v[152:155], v[52:55], v[96:99]
    v_mfma_f32_16x16x32_bf16 v[104:107], v[152:155], v[56:59], v[104:107]
    v_mfma_f32_16x16x32_bf16 v[112:115], v[152:155], v[60:63], v[112:115]
    v_mfma_f32_16x16x32_bf16 v[120:123], v[152:155], v[64:67], v[120:123]
    ds_read_b64_tr_b16 v[148:149], v5 offset:21568
    ds_read_b64_tr_b16 v[150:151], v5 offset:21504
    s_waitcnt lgkmcnt(14)
    v_mfma_f32_16x16x32_bf16 v[84:87], v[156:159], v[44:47], v[84:87]
    v_mfma_f32_16x16x32_bf16 v[92:95], v[156:159], v[48:51], v[92:95]
    v_mfma_f32_16x16x32_bf16 v[100:103], v[156:159], v[52:55], v[100:103]
    v_mfma_f32_16x16x32_bf16 v[108:111], v[156:159], v[56:59], v[108:111]
    v_mfma_f32_16x16x32_bf16 v[116:119], v[156:159], v[60:63], v[116:119]
    ds_read_b64_tr_b16 v[152:153], v5 offset:21824
    ds_read_b64_tr_b16 v[154:155], v5 offset:21760
    s_waitcnt lgkmcnt(14)
    v_mfma_f32_16x16x32_bf16 v[80:83], v[160:163], v[40:43], v[80:83]
    v_mfma_f32_16x16x32_bf16 v[88:91], v[160:163], v[44:47], v[88:91]
    v_mfma_f32_16x16x32_bf16 v[96:99], v[160:163], v[48:51], v[96:99]
    v_mfma_f32_16x16x32_bf16 v[104:107], v[160:163], v[52:55], v[104:107]
    v_mfma_f32_16x16x32_bf16 v[112:115], v[160:163], v[56:59], v[112:115]
    v_mfma_f32_16x16x32_bf16 v[120:123], v[160:163], v[60:63], v[120:123]
    ds_read_b64_tr_b16 v[156:157], v5 offset:22080
    ds_read_b64_tr_b16 v[158:159], v5 offset:22016
    s_waitcnt lgkmcnt(14)
    v_mfma_f32_16x16x32_bf16 v[84:87], v[124:127], v[40:43], v[84:87]
    v_mfma_f32_16x16x32_bf16 v[92:95], v[124:127], v[44:47], v[92:95]
    v_mfma_f32_16x16x32_bf16 v[100:103], v[124:127], v[48:51], v[100:103]
    v_mfma_f32_16x16x32_bf16 v[108:111], v[124:127], v[52:55], v[108:111]
    v_mfma_f32_16x16x32_bf16 v[116:119], v[124:127], v[56:59], v[116:119]
    ds_read_b64_tr_b16 v[160:161], v5 offset:22336
    ds_read_b64_tr_b16 v[162:163], v5 offset:22272
    s_waitcnt lgkmcnt(14)
    v_mfma_f32_16x16x32_bf16 v[80:83], v[128:131], v[36:39], v[80:83]
    v_mfma_f32_16x16x32_bf16 v[88:91], v[128:131], v[40:43], v[88:91]
    v_mfma_f32_16x16x32_bf16 v[96:99], v[128:131], v[44:47], v[96:99]
    v_mfma_f32_16x16x32_bf16 v[104:107], v[128:131], v[48:51], v[104:107]
    v_mfma_f32_16x16x32_bf16 v[112:115], v[128:131], v[52:55], v[112:115]
    v_mfma_f32_16x16x32_bf16 v[120:123], v[128:131], v[56:59], v[120:123]
    ds_read_b64_tr_b16 v[124:125], v5 offset:22592
    ds_read_b64_tr_b16 v[126:127], v5 offset:22528
    s_waitcnt lgkmcnt(14)
    v_mfma_f32_16x16x32_bf16 v[84:87], v[132:135], v[36:39], v[84:87]
    v_mfma_f32_16x16x32_bf16 v[92:95], v[132:135], v[40:43], v[92:95]
    v_mfma_f32_16x16x32_bf16 v[100:103], v[132:135], v[44:47], v[100:103]
    v_mfma_f32_16x16x32_bf16 v[108:111], v[132:135], v[48:51], v[108:111]
    v_mfma_f32_16x16x32_bf16 v[116:119], v[132:135], v[52:55], v[116:119]
    ds_read_b64_tr_b16 v[128:129], v5 offset:22848
    ds_read_b64_tr_b16 v[130:131], v5 offset:22784
    s_waitcnt lgkmcnt(14)
    v_mfma_f32_16x16x32_bf16 v[80:83], v[136:139], v[32:35], v[80:83]
    v_mfma_f32_16x16x32_bf16 v[88:91], v[136:139], v[36:39], v[88:91]
    v_mfma_f32_16x16x32_bf16 v[96:99], v[136:139], v[40:43], v[96:99]
    v_mfma_f32_16x16x32_bf16 v[104:107], v[136:139], v[44:47], v[104:107]
    v_mfma_f32_16x16x32_bf16 v[112:115], v[136:139], v[48:51], v[112:115]
    v_mfma_f32_16x16x32_bf16 v[120:123], v[136:139], v[52:55], v[120:123]
    ds_read_b64_tr_b16 v[132:133], v5 offset:23104
    ds_read_b64_tr_b16 v[134:135], v5 offset:23040
    s_waitcnt lgkmcnt(14)
    v_mfma_f32_16x16x32_bf16 v[84:87], v[140:143], v[32:35], v[84:87]
    v_mfma_f32_16x16x32_bf16 v[92:95], v[140:143], v[36:39], v[92:95]
    v_mfma_f32_16x16x32_bf16 v[100:103], v[140:143], v[40:43], v[100:103]
    v_mfma_f32_16x16x32_bf16 v[108:111], v[140:143], v[44:47], v[108:111]
    v_mfma_f32_16x16x32_bf16 v[116:119], v[140:143], v[48:51], v[116:119]
    ds_read_b64_tr_b16 v[136:137], v5 offset:23360
    ds_read_b64_tr_b16 v[138:139], v5 offset:23296
    s_waitcnt lgkmcnt(14)
    v_mfma_f32_16x16x32_bf16 v[80:83], v[144:147], v[28:31], v[80:83]
    v_mfma_f32_16x16x32_bf16 v[88:91], v[144:147], v[32:35], v[88:91]
    v_mfma_f32_16x16x32_bf16 v[96:99], v[144:147], v[36:39], v[96:99]
    v_mfma_f32_16x16x32_bf16 v[104:107], v[144:147], v[40:43], v[104:107]
    v_mfma_f32_16x16x32_bf16 v[112:115], v[144:147], v[44:47], v[112:115]
    v_mfma_f32_16x16x32_bf16 v[120:123], v[144:147], v[48:51], v[120:123]
    ds_read_b64_tr_b16 v[140:141], v5 offset:23616
    ds_read_b64_tr_b16 v[142:143], v5 offset:23552
    s_waitcnt lgkmcnt(14)
    v_mfma_f32_16x16x32_bf16 v[84:87], v[148:151], v[28:31], v[84:87]
    v_mfma_f32_16x16x32_bf16 v[92:95], v[148:151], v[32:35], v[92:95]
    v_mfma_f32_16x16x32_bf16 v[100:103], v[148:151], v[36:39], v[100:103]
    v_mfma_f32_16x16x32_bf16 v[108:111], v[148:151], v[40:43], v[108:111]
    v_mfma_f32_16x16x32_bf16 v[116:119], v[148:151], v[44:47], v[116:119]
    ds_read_b64_tr_b16 v[144:145], v5 offset:23872
    ds_read_b64_tr_b16 v[146:147], v5 offset:23808
    s_waitcnt lgkmcnt(14)
    v_mfma_f32_16x16x32_bf16 v[80:83], v[152:155], v[24:27], v[80:83]
    v_mfma_f32_16x16x32_bf16 v[88:91], v[152:155], v[28:31], v[88:91]
    v_mfma_f32_16x16x32_bf16 v[96:99], v[152:155], v[32:35], v[96:99]
    v_mfma_f32_16x16x32_bf16 v[104:107], v[152:155], v[36:39], v[104:107]
    v_mfma_f32_16x16x32_bf16 v[112:115], v[152:155], v[40:43], v[112:115]
    v_mfma_f32_16x16x32_bf16 v[120:123], v[152:155], v[44:47], v[120:123]
    ds_read_b64_tr_b16 v[148:149], v5 offset:24128
    ds_read_b64_tr_b16 v[150:151], v5 offset:24064
    s_waitcnt lgkmcnt(14)
    v_mfma_f32_16x16x32_bf16 v[84:87], v[156:159], v[24:27], v[84:87]
    v_mfma_f32_16x16x32_bf16 v[92:95], v[156:159], v[28:31], v[92:95]
    v_mfma_f32_16x16x32_bf16 v[100:103], v[156:159], v[32:35], v[100:103]
    v_mfma_f32_16x16x32_bf16 v[108:111], v[156:159], v[36:39], v[108:111]
    v_mfma_f32_16x16x32_bf16 v[116:119], v[156:159], v[40:43], v[116:119]
    ds_read_b64_tr_b16 v[152:153], v5 offset:24384
    ds_read_b64_tr_b16 v[154:155], v5 offset:24320
    s_waitcnt lgkmcnt(14)
    v_mfma_f32_16x16x32_bf16 v[80:83], v[160:163], v[20:23], v[80:83]
    v_mfma_f32_16x16x32_bf16 v[88:91], v[160:163], v[24:27], v[88:91]
    v_mfma_f32_16x16x32_bf16 v[96:99], v[160:163], v[28:31], v[96:99]
    v_mfma_f32_16x16x32_bf16 v[104:107], v[160:163], v[32:35], v[104:107]
    v_mfma_f32_16x16x32_bf16 v[112:115], v[160:163], v[36:39], v[112:115]
    v_mfma_f32_16x16x32_bf16 v[120:123], v[160:163], v[40:43], v[120:123]
    ds_read_b64_tr_b16 v[156:157], v5 offset:24640
    ds_read_b64_tr_b16 v[158:159], v5 offset:24576
    s_waitcnt lgkmcnt(14)
    v_mfma_f32_16x16x32_bf16 v[84:87], v[124:127], v[20:23], v[84:87]
    v_mfma_f32_16x16x32_bf16 v[92:95], v[124:127], v[24:27], v[92:95]
    v_mfma_f32_16x16x32_bf16 v[100:103], v[124:127], v[28:31], v[100:103]
    v_mfma_f32_16x16x32_bf16 v[108:111], v[124:127], v[32:35], v[108:111]
    v_mfma_f32_16x16x32_bf16 v[116:119], v[124:127], v[36:39], v[116:119]
    ds_read_b64_tr_b16 v[160:161], v5 offset:24896
    ds_read_b64_tr_b16 v[162:163], v5 offset:24832
    s_waitcnt lgkmcnt(14)
    v_mfma_f32_16x16x32_bf16 v[80:83], v[128:131], v[16:19], v[80:83]
    v_mfma_f32_16x16x32_bf16 v[88:91], v[128:131], v[20:23], v[88:91]
    v_mfma_f32_16x16x32_bf16 v[96:99], v[128:131], v[24:27], v[96:99]
    v_mfma_f32_16x16x32_bf16 v[104:107], v[128:131], v[28:31], v[104:107]
    v_mfma_f32_16x16x32_bf16 v[112:115], v[128:131], v[32:35], v[112:115]
    v_mfma_f32_16x16x32_bf16 v[120:123], v[128:131], v[36:39], v[120:123]
    ds_read_b64_tr_b16 v[124:125], v5 offset:25152
    ds_read_b64_tr_b16 v[126:127], v5 offset:25088
    s_waitcnt lgkmcnt(14)
    v_mfma_f32_16x16x32_bf16 v[84:87], v[132:135], v[16:19], v[84:87]
    v_mfma_f32_16x16x32_bf16 v[92:95], v[132:135], v[20:23], v[92:95]
    v_add_f32_dpp v15, v83, v82 wave_shr:1 row_mask:0xf bank_mask:0xf bound_ctrl:0
    v_mfma_f32_16x16x32_bf16 v[100:103], v[132:135], v[24:27], v[100:103]
    s_nop 0
    v_add_f32_dpp v13, v15, v81 wave_shr:1 row_mask:0xf bank_mask:0xf bound_ctrl:0
    v_mfma_f32_16x16x32_bf16 v[108:111], v[132:135], v[28:31], v[108:111]
    s_nop 1
    v_add_f32_dpp v14, v83, v86 wave_ror:1 row_mask:0xf bank_mask:0xf
    v_add_f32_dpp v12, v15, v85 wave_ror:1 row_mask:0xf bank_mask:0xf
    v_mfma_f32_16x16x32_bf16 v[116:119], v[132:135], v[32:35], v[116:119]
    v_add_f32_dpp v10, v13, v84 wave_ror:1 row_mask:0xf bank_mask:0xf
    v_add_f32_dpp v14, v87, v86 wave_shr:1 row_mask:0xf bank_mask:0xf
    ds_read_b64_tr_b16 v[128:129], v5 offset:25408
    ds_read_b64_tr_b16 v[130:131], v5 offset:25344
    s_waitcnt lgkmcnt(14)
    v_mfma_f32_16x16x32_bf16 v[88:91], v[136:139], v[16:19], v[88:91]
    v_mfma_f32_16x16x32_bf16 v[96:99], v[136:139], v[20:23], v[96:99]
    v_add_f32_dpp v12, v14, v85 wave_shr:1 row_mask:0xf bank_mask:0xf
    v_mfma_f32_16x16x32_bf16 v[104:107], v[136:139], v[24:27], v[104:107]
    s_nop 0
    v_add_f32_dpp v10, v12, v84 wave_shr:1 row_mask:0xf bank_mask:0xf
    v_mfma_f32_16x16x32_bf16 v[112:115], v[136:139], v[28:31], v[112:115]
    s_nop 1
    v_add_f32_dpp v15, v87, v90 wave_ror:1 row_mask:0xf bank_mask:0xf
    v_add_f32_dpp v13, v14, v89 wave_ror:1 row_mask:0xf bank_mask:0xf
    v_mfma_f32_16x16x32_bf16 v[120:123], v[136:139], v[32:35], v[120:123]
    v_add_f32_dpp v11, v12, v88 wave_ror:1 row_mask:0xf bank_mask:0xf
    v_add_f32_dpp v15, v91, v90 wave_shr:1 row_mask:0xf bank_mask:0xf
    s_waitcnt lgkmcnt(14)
    v_mfma_f32_16x16x32_bf16 v[92:95], v[140:143], v[16:19], v[92:95]
    v_mfma_f32_16x16x32_bf16 v[100:103], v[140:143], v[20:23], v[100:103]
    v_add_f32_dpp v13, v15, v89 wave_shr:1 row_mask:0xf bank_mask:0xf
    v_mfma_f32_16x16x32_bf16 v[108:111], v[140:143], v[24:27], v[108:111]
    s_nop 0
    v_add_f32_dpp v11, v13, v88 wave_shr:1 row_mask:0xf bank_mask:0xf
    v_cvt_pk_bf16_f32 v88, v10, v11
    v_mfma_f32_16x16x32_bf16 v[116:119], v[140:143], v[28:31], v[116:119]
    s_add_u32 s64, s72, 1444608
    buffer_store_dword v88, v7, s[44:47], s64 offen sc1
    v_add_f32_dpp v14, v91, v94 wave_ror:1 row_mask:0xf bank_mask:0xf
    v_add_f32_dpp v12, v15, v93 wave_ror:1 row_mask:0xf bank_mask:0xf
    s_waitcnt lgkmcnt(12)
    v_mfma_f32_16x16x32_bf16 v[96:99], v[144:147], v[16:19], v[96:99]
    v_add_f32_dpp v10, v13, v92 wave_ror:1 row_mask:0xf bank_mask:0xf
    v_add_f32_dpp v14, v95, v94 wave_shr:1 row_mask:0xf bank_mask:0xf
    v_mfma_f32_16x16x32_bf16 v[104:107], v[144:147], v[20:23], v[104:107]
    v_mfma_f32_16x16x32_bf16 v[112:115], v[144:147], v[24:27], v[112:115]
    v_add_f32_dpp v12, v14, v93 wave_shr:1 row_mask:0xf bank_mask:0xf
    v_mfma_f32_16x16x32_bf16 v[120:123], v[144:147], v[28:31], v[120:123]
    s_nop 0
    v_add_f32_dpp v10, v12, v92 wave_shr:1 row_mask:0xf bank_mask:0xf
    v_add_f32_dpp v15, v95, v98 wave_ror:1 row_mask:0xf bank_mask:0xf
    s_waitcnt lgkmcnt(10)
    v_mfma_f32_16x16x32_bf16 v[100:103], v[148:151], v[16:19], v[100:103]
    v_add_f32_dpp v13, v14, v97 wave_ror:1 row_mask:0xf bank_mask:0xf
    v_add_f32_dpp v11, v12, v96 wave_ror:1 row_mask:0xf bank_mask:0xf
    v_mfma_f32_16x16x32_bf16 v[108:111], v[148:151], v[20:23], v[108:111]
    v_add_f32_dpp v15, v99, v98 wave_shr:1 row_mask:0xf bank_mask:0xf
    v_mfma_f32_16x16x32_bf16 v[116:119], v[148:151], v[24:27], v[116:119]
    s_nop 0
    v_add_f32_dpp v13, v15, v97 wave_shr:1 row_mask:0xf bank_mask:0xf
    s_waitcnt lgkmcnt(8)
    v_mfma_f32_16x16x32_bf16 v[104:107], v[152:155], v[16:19], v[104:107]
    v_add_f32_dpp v11, v13, v96 wave_shr:1 row_mask:0xf bank_mask:0xf
    v_cvt_pk_bf16_f32 v96, v10, v11
    v_mfma_f32_16x16x32_bf16 v[112:115], v[152:155], v[20:23], v[112:115]
    s_add_u32 s64, s72, 1575936
    buffer_store_dword v96, v7, s[44:47], s64 offen sc1
    v_add_f32_dpp v14, v99, v102 wave_ror:1 row_mask:0xf bank_mask:0xf
    v_add_f32_dpp v12, v15, v101 wave_ror:1 row_mask:0xf bank_mask:0xf
    v_mfma_f32_16x16x32_bf16 v[120:123], v[152:155], v[24:27], v[120:123]
    v_add_f32_dpp v10, v13, v100 wave_ror:1 row_mask:0xf bank_mask:0xf
    v_add_f32_dpp v14, v103, v102 wave_shr:1 row_mask:0xf bank_mask:0xf
    s_waitcnt lgkmcnt(6)
    v_mfma_f32_16x16x32_bf16 v[108:111], v[156:159], v[16:19], v[108:111]
    v_mfma_f32_16x16x32_bf16 v[116:119], v[156:159], v[20:23], v[116:119]
    v_add_f32_dpp v12, v14, v101 wave_shr:1 row_mask:0xf bank_mask:0xf
    s_waitcnt lgkmcnt(4)
    v_mfma_f32_16x16x32_bf16 v[112:115], v[160:163], v[16:19], v[112:115]
    v_add_f32_dpp v10, v12, v100 wave_shr:1 row_mask:0xf bank_mask:0xf
    v_add_f32_dpp v15, v103, v106 wave_ror:1 row_mask:0xf bank_mask:0xf
    v_mfma_f32_16x16x32_bf16 v[120:123], v[160:163], v[20:23], v[120:123]
    v_add_f32_dpp v13, v14, v105 wave_ror:1 row_mask:0xf bank_mask:0xf
    v_add_f32_dpp v11, v12, v104 wave_ror:1 row_mask:0xf bank_mask:0xf
    s_waitcnt lgkmcnt(2)
    v_mfma_f32_16x16x32_bf16 v[116:119], v[124:127], v[16:19], v[116:119]
    v_add_f32_dpp v15, v107, v106 wave_shr:1 row_mask:0xf bank_mask:0xf
    s_waitcnt lgkmcnt(0)
    v_mfma_f32_16x16x32_bf16 v[120:123], v[128:131], v[16:19], v[120:123]
    v_add_f32_dpp v13, v15, v105 wave_shr:1 row_mask:0xf bank_mask:0xf
    s_nop 1
    v_add_f32_dpp v11, v13, v104 wave_shr:1 row_mask:0xf bank_mask:0xf
    v_cvt_pk_bf16_f32 v104, v10, v11
    s_add_u32 s64, s72, 1707264
    buffer_store_dword v104, v7, s[44:47], s64 offen sc1
    v_add_f32_dpp v14, v107, v110 wave_ror:1 row_mask:0xf bank_mask:0xf
    v_add_f32_dpp v12, v15, v109 wave_ror:1 row_mask:0xf bank_mask:0xf
    v_add_f32_dpp v10, v13, v108 wave_ror:1 row_mask:0xf bank_mask:0xf
    v_add_f32_dpp v14, v111, v110 wave_shr:1 row_mask:0xf bank_mask:0xf
    s_nop 1
    v_add_f32_dpp v12, v14, v109 wave_shr:1 row_mask:0xf bank_mask:0xf
    s_nop 1
    v_add_f32_dpp v10, v12, v108 wave_shr:1 row_mask:0xf bank_mask:0xf
    v_add_f32_dpp v15, v111, v114 wave_ror:1 row_mask:0xf bank_mask:0xf
    v_add_f32_dpp v13, v14, v113 wave_ror:1 row_mask:0xf bank_mask:0xf
    v_add_f32_dpp v11, v12, v112 wave_ror:1 row_mask:0xf bank_mask:0xf
    v_add_f32_dpp v15, v115, v114 wave_shr:1 row_mask:0xf bank_mask:0xf
    s_nop 1
    v_add_f32_dpp v13, v15, v113 wave_shr:1 row_mask:0xf bank_mask:0xf
    s_nop 1
    v_add_f32_dpp v11, v13, v112 wave_shr:1 row_mask:0xf bank_mask:0xf
    v_cvt_pk_bf16_f32 v112, v10, v11
    s_add_u32 s64, s72, 1838592
    buffer_store_dword v112, v7, s[44:47], s64 offen sc1
    v_add_f32_dpp v14, v115, v118 wave_ror:1 row_mask:0xf bank_mask:0xf
    v_add_f32_dpp v12, v15, v117 wave_ror:1 row_mask:0xf bank_mask:0xf
    v_add_f32_dpp v10, v13, v116 wave_ror:1 row_mask:0xf bank_mask:0xf
    v_add_f32_dpp v14, v119, v118 wave_shr:1 row_mask:0xf bank_mask:0xf
    s_nop 1
    v_add_f32_dpp v12, v14, v117 wave_shr:1 row_mask:0xf bank_mask:0xf
    s_nop 1
    v_add_f32_dpp v10, v12, v116 wave_shr:1 row_mask:0xf bank_mask:0xf
    v_add_f32_dpp v15, v119, v122 wave_ror:1 row_mask:0xf bank_mask:0xf
    v_add_f32_dpp v13, v14, v121 wave_ror:1 row_mask:0xf bank_mask:0xf
    v_add_f32_dpp v11, v12, v120 wave_ror:1 row_mask:0xf bank_mask:0xf
    v_add_f32_dpp v15, v123, v122 wave_shr:1 row_mask:0xf bank_mask:0xf
    s_nop 1
    v_add_f32_dpp v13, v15, v121 wave_shr:1 row_mask:0xf bank_mask:0xf
    s_nop 1
    v_add_f32_dpp v11, v13, v120 wave_shr:1 row_mask:0xf bank_mask:0xf
    v_cvt_pk_bf16_f32 v120, v10, v11
    s_add_u32 s64, s72, 1969920
    buffer_store_dword v120, v7, s[44:47], s64 offen sc1
L_convE:
    v_mov_b32 v8, 8
    s_mov_b64 exec, 1
    ds_write_b32 v3, v8 offset:31792
    s_mov_b64 exec, -1
    s_add_u32 s64, s43, 768
    s_lshl_b32 s64, s64, 7
    s_lshl_b32 s65, s67, 3
    s_add_u32 s64, s64, s65
    s_lshl_b32 s65, s66, 2
    s_add_u32 s64, s64, s65
    v_lshrrev_b32 v6, 3, v0
    v_and_b32 v10, 7, v0
    v_bfe_u32 v5, v0, 4, 1
    v_lshlrev_b32 v5, 2, v5
    v_xor_b32 v5, v5, v10
    v_lshlrev_b32 v5, 5, v5
    v_lshl_add_u32 v5, v6, 8, v5
    s_lshl_b32 s65, s41, 5
    s_lshl_b32 s70, s42, 3
    s_add_u32 s65, s65, s70
    s_add_u32 s65, s65, 768
    s_lshl_b32 s65, s65, 7
    s_cmp_ge_u32 s40, 22
    s_cselect_b32 s70, 8, 0
    s_add_u32 s65, s65, s70
    s_lshr_b32 s64, s43, 3
    s_lshl_b32 s64, s64, 12
    s_and_b32 s65, s37, 7
    s_lshl_b32 s65, s65, 3
    s_add_u32 s64, s64, s65
    s_lshl_b32 s65, s66, 2
    s_add_u32 s64, s64, s65
    s_add_u32 s64, s64, 393216
    v_lshlrev_b32 v8, 7, v0
    v_mov_b32 v9, s63
    s_mov_b32 s70, 0x003fffff
    s_not_b32 s71, s70
    s_cmp_eq_u32 s67, 0
    s_cselect_b32 s70, s70, s71
    s_lshl_b32 s65, s41, 2
    s_add_u32 s65, s65, s42
    s_lshl_b32 s65, s65, 5
    s_add_u32 s65, s65, s40
    s_lshl_b32 s65, s65, 7
    s_add_u32 s65, s65, 393216
    s_add_u32 s60, s34, s65
    s_addc_u32 s61, s35, 0
    s_mov_b32 s79, 100000
    v_lshl_add_u32 v11, v0, 2, s65
    s_waitcnt vmcnt(0)
    s_mov_b32 exec_lo, s70
    s_mov_b32 exec_hi, 0
    buffer_store_dword v9, v8, s[44:47], s64 offen sc1
    s_mov_b64 exec, -1
    s_setprio 0
    s_sleep 4
L_yq:
    s_load_dwordx16 s[8:23], s[60:61], 0 glc
    s_mov_b32 s62, 0
    s_waitcnt lgkmcnt(0)
    s_xor_b32 s8, s8, s63
    s_or_b32 s62, s62, s8
    s_xor_b32 s9, s9, s63
    s_or_b32 s62, s62, s9
    s_xor_b32 s10, s10, s63
    s_or_b32 s62, s62, s10
    s_xor_b32 s11, s11, s63
    s_or_b32 s62, s62, s11
    s_xor_b32 s12, s12, s63
    s_or_b32 s62, s62, s12
    s_xor_b32 s13, s13, s63
    s_or_b32 s62, s62, s13
    s_xor_b32 s14, s14, s63
    s_or_b32 s62, s62, s14
    s_xor_b32 s15, s15, s63
    s_or_b32 s62, s62, s15
    s_xor_b32 s16, s16, s63
    s_or_b32 s62, s62, s16
    s_xor_b32 s17, s17, s63
    s_or_b32 s62, s62, s17
    s_xor_b32 s18, s18, s63
    s_or_b32 s62, s62, s18
    s_xor_b32 s19, s19, s63
    s_or_b32 s62, s62, s19
    s_xor_b32 s20, s20, s63
    s_or_b32 s62, s62, s20
    s_xor_b32 s21, s21, s63
    s_or_b32 s62, s62, s21
    s_xor_b32 s22, s22, s63
    s_or_b32 s62, s62, s22
    s_xor_b32 s23, s23, s63
    s_or_b32 s62, s62, s23
    s_cbranch_scc0 L_yqd
    s_sub_u32 s79, s79, 1
    s_cbranch_scc1 L_yqd
    s_sleep 1
    s_branch L_yq
L_yqd:
    s_lshr_b32 s70, s40, 1
    s_mul_i32 s70, s70, 131328
    s_lshl_b32 s65, s41, 14
    s_add_u32 s70, s70, s65
    s_lshl_b32 s65, s42, 12
    s_add_u32 s70, s70, s65
    s_add_u32 s70, s70, 3407872
    s_lshr_b32 s65, s65, 1
    v_add_u32 v6, s65, v1
    buffer_load_dwordx4 v[16:19], v5, s[44:47], s70 offen offset:0 sc1
    buffer_load_dwordx4 v[20:23], v5, s[44:47], s70 offen offset:16 sc1
    buffer_load_dwordx4 v[24:27], v5, s[44:47], s70 offen offset:2048 sc1
    buffer_load_dwordx4 v[28:31], v5, s[44:47], s70 offen offset:2064 sc1
    s_bitcmp1_b32 s40, 0
    s_mov_b32 s64, 0x05040100
    s_cselect_b32 s64, 0x07060302, s64
    s_setprio 3
    s_mov_b32 s79, 400000
L_lw28:
    ds_read_b32 v8, v2 offset:31792
    s_waitcnt lgkmcnt(0)
    v_cmp_gt_u32 vcc, 8, v8
    s_sub_u32 s79, s79, 1
    s_cbranch_scc1 L_lwd28
    s_cbranch_vccz L_lwd28
    s_sleep 1
    s_branch L_lw28
L_lwd28:
    s_waitcnt vmcnt(0)
    v_perm_b32 v32, v17, v16, s64
    v_perm_b32 v33, v19, v18, s64
    v_perm_b32 v34, v21, v20, s64
    v_perm_b32 v35, v23, v22, s64
    v_perm_b32 v36, v25, v24, s64
    v_perm_b32 v37, v27, v26, s64
    v_perm_b32 v38, v29, v28, s64
    v_perm_b32 v39, v31, v30, s64
    ds_write_b128 v6, v[32:35] offset:16384
    ds_write_b128 v6, v[36:39] offset:17408
    v_mov_b32 v8, 9
    s_mov_b64 exec, 1
    ds_write_b32 v3, v8 offset:31792
    s_mov_b64 exec, -1
    s_endpgm
L_M:
    s_setprio 2
    v_mov_b32 v61, 0
    s_mov_b32 s46, 0x10000000
    s_mov_b32 s47, 0x20000
    s_mov_b32 s58, 0x00000100
    s_mov_b32 s59, 0x20000
    s_mov_b32 s44, s34
    s_mov_b32 s45, s35
    s_mov_b32 s56, s32
    s_mov_b32 s57, s33
    s_mov_b32 s48, s8
    s_mov_b32 s49, s9
    s_mov_b32 s50, 0x00200000
    s_mov_b32 s51, 0x20000
    v_bfe_u32 v16, v0, 2, 2
    v_and_b32 v17, 3, v0
    v_bfe_u32 v18, v0, 4, 1
    v_lshrrev_b32 v19, 5, v0
    v_and_b32 v20, 31, v0
    s_lshl_b32 s64, s40, 1
    s_add_u32 s64, s64, s66
    s_lshl_b32 s64, s64, 7
    s_add_u32 s64, s64, 196608
    v_and_b32 v164, 15, v0
    v_lshl_add_u32 v164, v164, 2, s64
    v_lshlrev_b32 v160, 2, v17
    s_lshl_b32 s64, s42, 2
    v_mov_b32 v161, s64
    v_lshl_add_u32 v21, v19, 3, v16
    v_lshlrev_b32 v21, 8, v21
    v_lshl_add_u32 v21, v18, 5, v21
    v_lshl_add_u32 v21, v17, 3, v21
    v_add_u32 v21, 81920, v21
    s_lshl_b32 s68, s66, 1
    v_xor_b32 v22, s68, v16
    v_lshl_add_u32 v2, v22, 6, v21
    v_xor_b32 v22, 1, v22
    v_lshl_add_u32 v3, v22, 6, v21
    s_lshl_b32 s68, s67, 13
    s_add_u32 s68, s68, 65536
    v_lshlrev_b32 v21, 7, v20
    v_add_u32 v21, s68, v21
    v_bfe_u32 v22, v0, 1, 3
    v_xor_b32 v22, v22, v19
    v_xor_b32 v23, 0, v22
    v_lshl_add_u32 v4, v23, 4, v21
    v_xor_b32 v23, 2, v22
    v_lshl_add_u32 v5, v23, 4, v21
    v_xor_b32 v23, 4, v22
    v_lshl_add_u32 v6, v23, 4, v21
    v_xor_b32 v23, 6, v22
    v_lshl_add_u32 v7, v23, 4, v21
    v_lshlrev_b32 v21, 3, v20
    s_lshl_b32 s68, s66, 8
    v_lshl_add_u32 v22, v19, 4, s68
    v_mov_b32 v12, 1.0
    v_mov_b32 v13, 1.0
    v_mov_b32 v14, 0xbfb17218
    s_lshl_b32 s68, s38, 2
    s_lshl_b32 s69, s67, 1
    s_add_u32 s68, s68, s69
    s_mul_i32 s68, s68, 112
    s_lshl_b32 s69, s39, 3
    s_add_u32 s68, s68, s69
    s_lshl_b32 s69, s66, 2
    s_add_u32 s68, s68, s69
    s_lshl_b32 s68, s68, 10
    s_add_u32 s68, s68, 5767168
    s_add_u32 s69, s68, 114688
    v_mov_b32 v163, 8
    v_mov_b32 v64, 0
    v_mov_b32 v65, 0
    v_mov_b32 v66, 0
    v_mov_b32 v67, 0
    v_mov_b32 v68, 0
    v_mov_b32 v69, 0
    v_mov_b32 v70, 0
    v_mov_b32 v71, 0
    v_mov_b32 v72, 0
    v_mov_b32 v73, 0
    v_mov_b32 v74, 0
    v_mov_b32 v75, 0
    v_mov_b32 v76, 0
    v_mov_b32 v77, 0
    v_mov_b32 v78, 0
    v_mov_b32 v79, 0
    v_mov_b32 v80, 0
    v_mov_b32 v81, 0
    v_mov_b32 v82, 0
    v_mov_b32 v83, 0
    v_mov_b32 v84, 0
    v_mov_b32 v85, 0
    v_mov_b32 v86, 0
    v_mov_b32 v87, 0
    v_mov_b32 v88, 0
    v_mov_b32 v89, 0
    v_mov_b32 v90, 0
    v_mov_b32 v91, 0
    v_mov_b32 v92, 0
    v_mov_b32 v93, 0
    v_mov_b32 v94, 0
    v_mov_b32 v95, 0
    v_mov_b32 v96, 0
    v_mov_b32 v97, 0
    v_mov_b32 v98, 0
    v_mov_b32 v99, 0
    v_mov_b32 v100, 0
    v_mov_b32 v101, 0
    v_mov_b32 v102, 0
    v_mov_b32 v103, 0
    v_mov_b32 v104, 0
    v_mov_b32 v105, 0
    v_mov_b32 v106, 0
    v_mov_b32 v107, 0
    v_mov_b32 v108, 0
    v_mov_b32 v109, 0
    v_mov_b32 v110, 0
    v_mov_b32 v111, 0
    v_mov_b32 v112, 0
    v_mov_b32 v113, 0
    v_mov_b32 v114, 0
    v_mov_b32 v115, 0
    v_mov_b32 v116, 0
    v_mov_b32 v117, 0
    v_mov_b32 v118, 0
    v_mov_b32 v119, 0
    v_mov_b32 v120, 0
    v_mov_b32 v121, 0
    v_mov_b32 v122, 0
    v_mov_b32 v123, 0
    v_mov_b32 v124, 0
    v_mov_b32 v125, 0
    v_mov_b32 v126, 0
    v_mov_b32 v127, 0
    v_mov_b32 v60, 0x3f317218
    s_lshl_b32 s74, s38, 10
    s_lshl_b32 s65, s67, 9
    s_add_u32 s74, s74, s65
    s_add_u32 s74, s74, 131072
    s_waitcnt vmcnt(0)
    v_lshlrev_b32 v24, 16, v128
    v_and_b32 v25, 0xffff0000, v128
    v_lshlrev_b32 v26, 16, v129
    v_and_b32 v27, 0xffff0000, v129
    v_lshlrev_b32 v28, 16, v130
    v_and_b32 v29, 0xffff0000, v130
    v_lshlrev_b32 v30, 16, v131
    v_and_b32 v31, 0xffff0000, v131
    v_lshlrev_b32 v32, 16, v132
    v_and_b32 v33, 0xffff0000, v132
    v_lshlrev_b32 v34, 16, v133
    v_and_b32 v35, 0xffff0000, v133
    v_lshlrev_b32 v36, 16, v134
    v_and_b32 v37, 0xffff0000, v134
    v_lshlrev_b32 v38, 16, v135
    v_and_b32 v39, 0xffff0000, v135
    v_pk_add_f32 v[40:41], v[24:25], v[32:33]
    v_pk_add_f32 v[42:43], v[26:27], v[34:35]
    v_pk_add_f32 v[44:45], v[28:29], v[36:37]
    v_pk_add_f32 v[46:47], v[30:31], v[38:39]
    v_pk_add_f32 v[40:41], v[40:41], v[44:45]
    v_pk_add_f32 v[42:43], v[42:43], v[46:47]
    v_pk_add_f32 v[136:137], v[40:41], v[42:43]
    v_add_f32 v136, v136, v137
    s_nop 1
    v_add_f32_dpp v136, v136, v136 quad_perm:[1,0,3,2] row_mask:0xf bank_mask:0xf
    s_nop 1
    v_add_f32_dpp v136, v136, v136 quad_perm:[2,3,0,1] row_mask:0xf bank_mask:0xf
    s_nop 1
    v_add_f32_dpp v136, v136, v136 row_half_mirror row_mask:0xf bank_mask:0xf
    s_nop 1
    v_add_f32_dpp v136, v136, v136 row_mirror row_mask:0xf bank_mask:0xf
    v_mov_b32 v137, v136
    s_nop 1
    v_permlane16_swap_b32 v136, v137
    v_add_f32 v136, v136, v137
    v_mul_f32 v136, 0x3b000000, v136
    v_pk_add_f32 v[40:41], v[24:25], v[136:137] op_sel_hi:[1,0] neg_lo:[0,1] neg_hi:[0,1]
    v_pk_add_f32 v[42:43], v[26:27], v[136:137] op_sel_hi:[1,0] neg_lo:[0,1] neg_hi:[0,1]
    v_pk_add_f32 v[44:45], v[28:29], v[136:137] op_sel_hi:[1,0] neg_lo:[0,1] neg_hi:[0,1]
    v_pk_add_f32 v[46:47], v[30:31], v[136:137] op_sel_hi:[1,0] neg_lo:[0,1] neg_hi:[0,1]
    v_pk_add_f32 v[48:49], v[32:33], v[136:137] op_sel_hi:[1,0] neg_lo:[0,1] neg_hi:[0,1]
    v_pk_add_f32 v[50:51], v[34:35], v[136:137] op_sel_hi:[1,0] neg_lo:[0,1] neg_hi:[0,1]
    v_pk_add_f32 v[52:53], v[36:37], v[136:137] op_sel_hi:[1,0] neg_lo:[0,1] neg_hi:[0,1]
    v_pk_add_f32 v[54:55], v[38:39], v[136:137] op_sel_hi:[1,0] neg_lo:[0,1] neg_hi:[0,1]
    v_pk_mul_f32 v[138:139], v[40:41], v[40:41]
    v_pk_fma_f32 v[138:139], v[42:43], v[42:43], v[138:139]
    v_pk_fma_f32 v[138:139], v[44:45], v[44:45], v[138:139]
    v_pk_fma_f32 v[138:139], v[46:47], v[46:47], v[138:139]
    v_pk_fma_f32 v[138:139], v[48:49], v[48:49], v[138:139]
    v_pk_fma_f32 v[138:139], v[50:51], v[50:51], v[138:139]
    v_pk_fma_f32 v[138:139], v[52:53], v[52:53], v[138:139]
    v_pk_fma_f32 v[138:139], v[54:55], v[54:55], v[138:139]
    v_cvt_pk_bf16_f32 v136, v136, v136
    v_and_b32 v136, 0xffff0000, v136
    v_add_f32 v138, v138, v139
    s_nop 1
    v_add_f32_dpp v138, v138, v138 quad_perm:[1,0,3,2] row_mask:0xf bank_mask:0xf
    s_nop 1
    v_add_f32_dpp v138, v138, v138 quad_perm:[2,3,0,1] row_mask:0xf bank_mask:0xf
    s_nop 1
    v_add_f32_dpp v138, v138, v138 row_half_mirror row_mask:0xf bank_mask:0xf
    s_nop 1
    v_add_f32_dpp v138, v138, v138 row_mirror row_mask:0xf bank_mask:0xf
    v_mov_b32 v139, v138
    s_nop 1
    v_permlane16_swap_b32 v138, v139
    v_add_f32 v138, v138, v139
    v_mul_f32 v138, 0x3b000000, v138
    v_cvt_pk_bf16_f32 v138, v138, v138
    v_and_b32 v138, 0xffff0000, v138
    v_add_f32 v138, 0x3727c5ac, v138
    v_cvt_pk_bf16_f32 v138, v138, v138
    v_and_b32 v138, 0xffff0000, v138
    v_sqrt_f32 v138, v138
    v_lshrrev_b32 v136, 16, v136
    v_cvt_pk_bf16_f32 v138, v138, v138
    v_and_b32 v138, 0xffff0000, v138
    v_or_b32 v58, v136, v138
    s_lshl_b32 s65, s42, 3
    v_lshl_add_u32 v23, v19, 2, s65
    s_mov_b32 exec_lo, 1
    s_mov_b32 exec_hi, 1
    ds_write_b32 v23, v58 offset:31840
    s_mov_b64 exec, -1
    s_cmp_ge_u32 s37, 28
    s_cbranch_scc1 L_Mhelper
    s_mov_b32 s64, 0
    s_mov_b32 s73, 0x8000
    s_waitcnt lgkmcnt(0)
    s_barrier
    ds_read_b64_tr_b16 v[24:25], v2 offset:0
    ds_read_b64_tr_b16 v[26:27], v2 offset:1024
    ds_read_b128 v[32:35], v4
    ds_read_b128 v[36:39], v4 offset:4096
    ds_read_b64_tr_b16 v[28:29], v3 offset:0
    ds_read_b64_tr_b16 v[30:31], v3 offset:1024
    ds_read_b64_tr_b16 v[40:41], v2 offset:4096
    ds_read_b64_tr_b16 v[42:43], v2 offset:5120
    ds_read_b128 v[48:51], v5
    ds_read_b128 v[52:55], v5 offset:4096
    ds_read_b64_tr_b16 v[44:45], v3 offset:4096
    ds_read_b64_tr_b16 v[46:47], v3 offset:5120
.p2align 3
L_g1:
    s_waitcnt lgkmcnt(6)
    v_mfma_f32_32x32x16_bf16 v[64:79], v[24:27], v[32:35], v[64:79]
    ds_read_b64_tr_b16 v[128:129], v2 offset:8192
    ds_read_b64_tr_b16 v[130:131], v2 offset:9216
    v_mfma_f32_32x32x16_bf16 v[80:95], v[24:27], v[36:39], v[80:95]
    ds_read_b128 v[136:139], v6
    ds_read_b128 v[140:143], v6 offset:4096
    v_mfma_f32_32x32x16_bf16 v[96:111], v[28:31], v[32:35], v[96:111]
    ds_read_b64_tr_b16 v[132:133], v3 offset:8192
    ds_read_b64_tr_b16 v[134:135], v3 offset:9216
    s_cmp_lg_u32 s64, 6
    s_cbranch_scc1 L_g1ns
    buffer_load_dwordx2 v[8:9], v21, s[44:47], s74 offen sc1
    buffer_load_dwordx2 v[10:11], v21, s[44:47], s74 offen offset:256 sc1
    buffer_load_dword v167, v164, s[44:47], 0 offen
    s_load_dword s63, s[32:33], 0
L_g1ns:
    s_add_u32 s64, s64, 1
    s_and_b32 s65, s64, 3
    s_cmp_eq_u32 s65, 3
    s_cselect_b32 s65, 0xfffe8000, s73
    v_mfma_f32_32x32x16_bf16 v[112:127], v[28:31], v[36:39], v[112:127]
    s_waitcnt lgkmcnt(6)
    v_mfma_f32_32x32x16_bf16 v[64:79], v[40:43], v[48:51], v[64:79]
    ds_read_b64_tr_b16 v[144:145], v2 offset:12288
    ds_read_b64_tr_b16 v[146:147], v2 offset:13312
    v_mfma_f32_32x32x16_bf16 v[80:95], v[40:43], v[52:55], v[80:95]
    ds_read_b128 v[152:155], v7
    ds_read_b128 v[156:159], v7 offset:4096
    v_mfma_f32_32x32x16_bf16 v[96:111], v[44:47], v[48:51], v[96:111]
    ds_read_b64_tr_b16 v[148:149], v3 offset:12288
    ds_read_b64_tr_b16 v[150:151], v3 offset:13312
    v_mfma_f32_32x32x16_bf16 v[112:127], v[44:47], v[52:55], v[112:127]
    v_add_u32 v2, s65, v2
    v_add_u32 v3, s65, v3
    v_add_u32 v4, s65, v4
    v_add_u32 v5, s65, v5
    v_add_u32 v6, s65, v6
    v_add_u32 v7, s65, v7
    s_waitcnt lgkmcnt(6)
    v_mfma_f32_32x32x16_bf16 v[64:79], v[128:131], v[136:139], v[64:79]
    s_cmp_eq_u32 s64, 8
    s_cbranch_scc1 L_g1tail
    s_barrier
    ds_read_b64_tr_b16 v[24:25], v2 offset:0
    ds_read_b64_tr_b16 v[26:27], v2 offset:1024
    v_mfma_f32_32x32x16_bf16 v[80:95], v[128:131], v[140:143], v[80:95]
    ds_read_b128 v[32:35], v4
    ds_read_b128 v[36:39], v4 offset:4096
    v_mfma_f32_32x32x16_bf16 v[96:111], v[132:135], v[136:139], v[96:111]
    ds_read_b64_tr_b16 v[28:29], v3 offset:0
    ds_read_b64_tr_b16 v[30:31], v3 offset:1024
    v_mfma_f32_32x32x16_bf16 v[112:127], v[132:135], v[140:143], v[112:127]
    s_waitcnt lgkmcnt(6)
    v_mfma_f32_32x32x16_bf16 v[64:79], v[144:147], v[152:155], v[64:79]
    ds_read_b64_tr_b16 v[40:41], v2 offset:4096
    ds_read_b64_tr_b16 v[42:43], v2 offset:5120
    v_mfma_f32_32x32x16_bf16 v[80:95], v[144:147], v[156:159], v[80:95]
    ds_read_b128 v[48:51], v5
    ds_read_b128 v[52:55], v5 offset:4096
    v_mfma_f32_32x32x16_bf16 v[96:111], v[148:151], v[152:155], v[96:111]
    ds_read_b64_tr_b16 v[44:45], v3 offset:4096
    ds_read_b64_tr_b16 v[46:47], v3 offset:5120
    v_mfma_f32_32x32x16_bf16 v[112:127], v[148:151], v[156:159], v[112:127]
    s_branch L_g1
L_g1tail:
    s_waitcnt lgkmcnt(0)
    v_mfma_f32_32x32x16_bf16 v[80:95], v[128:131], v[140:143], v[80:95]
    ds_read_b128 v[40:43], v22 offset:31232
    ds_read_b128 v[44:47], v22 offset:31264
    ds_read_b128 v[48:51], v22 offset:31296
    ds_read_b128 v[52:55], v22 offset:31328
    s_cmp_lg_u32 s63, 0
    s_cbranch_scc1 L_tf29
    v_mov_b32 v61, 0
    s_mov_b64 exec, 1
    s_mov_b32 s79, 100000
L_poll30:
    buffer_load_dword v62, v61, s[56:59], 0 offen sc1
    s_waitcnt vmcnt(0)
    v_cmp_eq_u32 vcc, 0, v62
    s_sub_u32 s79, s79, 1
    s_cbranch_scc1 L_polled30
    s_cmp_eq_u64 vcc, 0
    s_cbranch_scc1 L_polled30
    s_sleep 8
    s_branch L_poll30
L_polled30:
    s_mov_b64 exec, -1
    v_readfirstlane_b32 s63, v62
    s_nop 1
L_tf29:
    s_mov_b32 s79, 100000
L_stat:
    s_waitcnt vmcnt(0)
    v_cmp_ne_u32 vcc, s63, v9
    v_cmp_ne_u32 s[64:65], s63, v11
    s_nop 0
    s_or_b64 vcc, vcc, s[64:65]
    s_cbranch_scc0 L_stat_ok
    s_sub_u32 s79, s79, 1
    s_cbranch_scc1 L_stat_ok
    buffer_load_dwordx2 v[8:9], v21, s[44:47], s74 offen sc1
    buffer_load_dwordx2 v[10:11], v21, s[44:47], s74 offen offset:256 sc1
    s_branch L_stat
L_stat_ok:
    v_lshlrev_b32 v56, 16, v8
    v_lshlrev_b32 v58, 16, v10
    v_and_b32 v8, 0xffff0000, v8
    v_and_b32 v10, 0xffff0000, v10
    v_mfma_f32_32x32x16_bf16 v[96:111], v[132:135], v[136:139], v[96:111]
    v_rcp_f32 v8, v8
    v_rcp_f32 v10, v10
    v_mfma_f32_32x32x16_bf16 v[112:127], v[132:135], v[140:143], v[112:127]
    v_mul_f32 v8, 0x3fb8aa3b, v8
    v_mul_f32 v10, 0x3fb8aa3b, v10
    v_mul_f32 v56, v56, v8
    v_mul_f32 v58, v58, v10
    v_mfma_f32_32x32x16_bf16 v[64:79], v[144:147], v[152:155], v[64:79]
    ds_read_b32 v162, v160 offset:31776
    v_mfma_f32_32x32x16_bf16 v[80:95], v[144:147], v[156:159], v[80:95]
    v_mfma_f32_32x32x16_bf16 v[96:111], v[148:151], v[152:155], v[96:111]
    s_waitcnt lgkmcnt(0)
    v_cmp_gt_u32 vcc, 1, v162
    v_mfma_f32_32x32x16_bf16 v[112:127], v[148:151], v[156:159], v[112:127]
    s_cbranch_vccz L_csok
    s_mov_b32 s79, 400000
L_lw31:
    ds_read_b32 v162, v160 offset:31776
    s_waitcnt lgkmcnt(0)
    v_cmp_gt_u32 vcc, 1, v162
    s_sub_u32 s79, s79, 1
    s_cbranch_scc1 L_lwd31
    s_cbranch_vccnz L_lw31
L_lwd31:
L_csok:
    ds_read_b128 v[24:27], v22 offset:30720
    ds_read_b128 v[28:31], v22 offset:30752
    ds_read_b128 v[32:35], v22 offset:30784
    ds_read_b128 v[36:39], v22 offset:30816
    s_mov_b64 exec, 1
    ds_write_b32 v161, v163 offset:31760
    s_mov_b64 exec, -1
    s_lshl_b32 s73, s38, 1
    s_add_u32 s73, s73, s67
    s_mul_i32 s74, s73, 14
    s_add_u32 s74, s74, s39
    s_lshl_b32 s74, s74, 7
    s_lshl_b32 s65, s66, 2
    s_add_u32 s74, s74, s65
    s_add_u32 s74, s74, 262144
    s_lshl_b32 s73, s73, 8
    s_add_u32 s73, s73, s65
    s_lshl_b32 s65, s39, 3
    s_add_u32 s73, s73, s65
    s_cmp_ge_u32 s39, 7
    s_cselect_b32 s65, 72, 0
    s_add_u32 s73, s73, s65
    s_add_u32 s73, s73, 196608
    v_mov_b32 v165, 0
    v_mov_b32 v166, s63
    v_and_b32 v62, 15, v0
    v_lshlrev_b32 v62, 7, v62
    v_mul_u32_u24 v63, 114688, v18
    v_add3_u32 v62, v62, v63, s68
    s_waitcnt lgkmcnt(3)
.p2align 3
    v_pk_fma_f32 v[128:129], v[24:25], v[56:57], v[40:41] op_sel_hi:[1,0,1] neg_lo:[0,1,0] neg_hi:[0,1,0]
    v_pk_fma_f32 v[130:131], v[26:27], v[56:57], v[42:43] op_sel_hi:[1,0,1] neg_lo:[0,1,0] neg_hi:[0,1,0]
    v_pk_fma_f32 v[132:133], v[28:29], v[56:57], v[44:45] op_sel_hi:[1,0,1] neg_lo:[0,1,0] neg_hi:[0,1,0]
    v_pk_fma_f32 v[134:135], v[30:31], v[56:57], v[46:47] op_sel_hi:[1,0,1] neg_lo:[0,1,0] neg_hi:[0,1,0]
    v_pk_fma_f32 v[128:129], v[64:65], v[8:9], v[128:129] op_sel_hi:[1,0,1]
    v_pk_fma_f32 v[130:131], v[66:67], v[8:9], v[130:131] op_sel_hi:[1,0,1]
    v_pk_fma_f32 v[132:133], v[68:69], v[8:9], v[132:133] op_sel_hi:[1,0,1]
    v_pk_fma_f32 v[134:135], v[70:71], v[8:9], v[134:135] op_sel_hi:[1,0,1]
    v_exp_f32 v136, v128
    v_exp_f32 v137, v129
    v_exp_f32 v138, v130
    v_exp_f32 v139, v131
    v_exp_f32 v140, v132
    v_exp_f32 v141, v133
    v_exp_f32 v142, v134
    v_exp_f32 v143, v135
    v_pk_add_f32 v[136:137], v[136:137], v[12:13]
    v_pk_add_f32 v[138:139], v[138:139], v[12:13]
    v_pk_add_f32 v[140:141], v[140:141], v[12:13]
    v_pk_add_f32 v[142:143], v[142:143], v[12:13]
    v_pk_fma_f32 v[136:137], v[136:137], v[136:137], v[12:13]
    v_pk_fma_f32 v[138:139], v[138:139], v[138:139], v[12:13]
    v_pk_fma_f32 v[140:141], v[140:141], v[140:141], v[12:13]
    v_pk_fma_f32 v[142:143], v[142:143], v[142:143], v[12:13]
    v_rcp_f32 v136, v136
    v_rcp_f32 v137, v137
    v_rcp_f32 v138, v138
    v_rcp_f32 v139, v139
    v_rcp_f32 v140, v140
    v_rcp_f32 v141, v141
    v_rcp_f32 v142, v142
    v_rcp_f32 v143, v143
    v_pk_fma_f32 v[136:137], v[136:137], v[14:15], v[60:61] op_sel_hi:[1,0,0]
    v_pk_fma_f32 v[138:139], v[138:139], v[14:15], v[60:61] op_sel_hi:[1,0,0]
    v_pk_fma_f32 v[140:141], v[140:141], v[14:15], v[60:61] op_sel_hi:[1,0,0]
    v_pk_fma_f32 v[142:143], v[142:143], v[14:15], v[60:61] op_sel_hi:[1,0,0]
    v_pk_mul_f32 v[128:129], v[128:129], v[136:137]
    v_pk_mul_f32 v[130:131], v[130:131], v[138:139]
    v_pk_mul_f32 v[132:133], v[132:133], v[140:141]
    v_pk_mul_f32 v[134:135], v[134:135], v[142:143]
    v_cvt_pk_bf16_f32 v144, v128, v129
    v_cvt_pk_bf16_f32 v145, v130, v131
    v_cvt_pk_bf16_f32 v146, v132, v133
    v_cvt_pk_bf16_f32 v147, v134, v135
    buffer_store_dwordx4 v[144:147], v1, s[44:47], s68 offen offset:0 sc1
    s_waitcnt lgkmcnt(1)
    s_nop 0
    v_pk_fma_f32 v[128:129], v[32:33], v[56:57], v[48:49] op_sel_hi:[1,0,1] neg_lo:[0,1,0] neg_hi:[0,1,0]
    v_pk_fma_f32 v[130:131], v[34:35], v[56:57], v[50:51] op_sel_hi:[1,0,1] neg_lo:[0,1,0] neg_hi:[0,1,0]
    v_pk_fma_f32 v[132:133], v[36:37], v[56:57], v[52:53] op_sel_hi:[1,0,1] neg_lo:[0,1,0] neg_hi:[0,1,0]
    v_pk_fma_f32 v[134:135], v[38:39], v[56:57], v[54:55] op_sel_hi:[1,0,1] neg_lo:[0,1,0] neg_hi:[0,1,0]
    v_pk_fma_f32 v[128:129], v[72:73], v[8:9], v[128:129] op_sel_hi:[1,0,1]
    v_pk_fma_f32 v[130:131], v[74:75], v[8:9], v[130:131] op_sel_hi:[1,0,1]
    v_pk_fma_f32 v[132:133], v[76:77], v[8:9], v[132:133] op_sel_hi:[1,0,1]
    v_pk_fma_f32 v[134:135], v[78:79], v[8:9], v[134:135] op_sel_hi:[1,0,1]
    v_exp_f32 v136, v128
    v_exp_f32 v137, v129
    v_exp_f32 v138, v130
    v_exp_f32 v139, v131
    v_exp_f32 v140, v132
    v_exp_f32 v141, v133
    v_exp_f32 v142, v134
    v_exp_f32 v143, v135
    v_pk_add_f32 v[136:137], v[136:137], v[12:13]
    v_pk_add_f32 v[138:139], v[138:139], v[12:13]
    v_pk_add_f32 v[140:141], v[140:141], v[12:13]
    v_pk_add_f32 v[142:143], v[142:143], v[12:13]
    v_pk_fma_f32 v[136:137], v[136:137], v[136:137], v[12:13]
    v_pk_fma_f32 v[138:139], v[138:139], v[138:139], v[12:13]
    v_pk_fma_f32 v[140:141], v[140:141], v[140:141], v[12:13]
    v_pk_fma_f32 v[142:143], v[142:143], v[142:143], v[12:13]
    v_rcp_f32 v136, v136
    v_rcp_f32 v137, v137
    v_rcp_f32 v138, v138
    v_rcp_f32 v139, v139
    v_rcp_f32 v140, v140
    v_rcp_f32 v141, v141
    v_rcp_f32 v142, v142
    v_rcp_f32 v143, v143
    v_pk_fma_f32 v[136:137], v[136:137], v[14:15], v[60:61] op_sel_hi:[1,0,0]
    v_pk_fma_f32 v[138:139], v[138:139], v[14:15], v[60:61] op_sel_hi:[1,0,0]
    v_pk_fma_f32 v[140:141], v[140:141], v[14:15], v[60:61] op_sel_hi:[1,0,0]
    v_pk_fma_f32 v[142:143], v[142:143], v[14:15], v[60:61] op_sel_hi:[1,0,0]
    v_pk_mul_f32 v[128:129], v[128:129], v[136:137]
    v_pk_mul_f32 v[130:131], v[130:131], v[138:139]
    v_pk_mul_f32 v[132:133], v[132:133], v[140:141]
    v_pk_mul_f32 v[134:135], v[134:135], v[142:143]
    v_cvt_pk_bf16_f32 v148, v128, v129
    v_cvt_pk_bf16_f32 v149, v130, v131
    v_cvt_pk_bf16_f32 v150, v132, v133
    v_cvt_pk_bf16_f32 v151, v134, v135
    buffer_store_dwordx4 v[148:151], v1, s[44:47], s68 offen offset:1024 sc1
    v_pk_fma_f32 v[128:129], v[24:25], v[58:59], v[40:41] op_sel_hi:[1,0,1] neg_lo:[0,1,0] neg_hi:[0,1,0]
    v_pk_fma_f32 v[130:131], v[26:27], v[58:59], v[42:43] op_sel_hi:[1,0,1] neg_lo:[0,1,0] neg_hi:[0,1,0]
    v_pk_fma_f32 v[132:133], v[28:29], v[58:59], v[44:45] op_sel_hi:[1,0,1] neg_lo:[0,1,0] neg_hi:[0,1,0]
    v_pk_fma_f32 v[134:135], v[30:31], v[58:59], v[46:47] op_sel_hi:[1,0,1] neg_lo:[0,1,0] neg_hi:[0,1,0]
    ds_read_b128 v[24:27], v22 offset:30848
    ds_read_b128 v[40:43], v22 offset:31360
    ds_read_b128 v[28:31], v22 offset:30880
    ds_read_b128 v[44:47], v22 offset:31392
    v_pk_fma_f32 v[128:129], v[80:81], v[10:11], v[128:129] op_sel_hi:[1,0,1]
    v_pk_fma_f32 v[130:131], v[82:83], v[10:11], v[130:131] op_sel_hi:[1,0,1]
    v_pk_fma_f32 v[132:133], v[84:85], v[10:11], v[132:133] op_sel_hi:[1,0,1]
    v_pk_fma_f32 v[134:135], v[86:87], v[10:11], v[134:135] op_sel_hi:[1,0,1]
    v_exp_f32 v136, v128
    v_exp_f32 v137, v129
    v_exp_f32 v138, v130
    v_exp_f32 v139, v131
    v_exp_f32 v140, v132
    v_exp_f32 v141, v133
    v_exp_f32 v142, v134
    v_exp_f32 v143, v135
    v_pk_add_f32 v[136:137], v[136:137], v[12:13]
    v_pk_add_f32 v[138:139], v[138:139], v[12:13]
    v_pk_add_f32 v[140:141], v[140:141], v[12:13]
    v_pk_add_f32 v[142:143], v[142:143], v[12:13]
    v_pk_fma_f32 v[136:137], v[136:137], v[136:137], v[12:13]
    v_pk_fma_f32 v[138:139], v[138:139], v[138:139], v[12:13]
    v_pk_fma_f32 v[140:141], v[140:141], v[140:141], v[12:13]
    v_pk_fma_f32 v[142:143], v[142:143], v[142:143], v[12:13]
    v_rcp_f32 v136, v136
    v_rcp_f32 v137, v137
    v_rcp_f32 v138, v138
    v_rcp_f32 v139, v139
    v_rcp_f32 v140, v140
    v_rcp_f32 v141, v141
    v_rcp_f32 v142, v142
    v_rcp_f32 v143, v143
    v_pk_fma_f32 v[136:137], v[136:137], v[14:15], v[60:61] op_sel_hi:[1,0,0]
    v_pk_fma_f32 v[138:139], v[138:139], v[14:15], v[60:61] op_sel_hi:[1,0,0]
    v_pk_fma_f32 v[140:141], v[140:141], v[14:15], v[60:61] op_sel_hi:[1,0,0]
    v_pk_fma_f32 v[142:143], v[142:143], v[14:15], v[60:61] op_sel_hi:[1,0,0]
    v_pk_mul_f32 v[128:129], v[128:129], v[136:137]
    v_pk_mul_f32 v[130:131], v[130:131], v[138:139]
    v_pk_mul_f32 v[132:133], v[132:133], v[140:141]
    v_pk_mul_f32 v[134:135], v[134:135], v[142:143]
    v_cvt_pk_bf16_f32 v144, v128, v129
    v_cvt_pk_bf16_f32 v145, v130, v131
    v_cvt_pk_bf16_f32 v146, v132, v133
    v_cvt_pk_bf16_f32 v147, v134, v135
    buffer_store_dwordx4 v[144:147], v1, s[44:47], s69 offen offset:0 sc1
    v_pk_fma_f32 v[128:129], v[32:33], v[58:59], v[48:49] op_sel_hi:[1,0,1] neg_lo:[0,1,0] neg_hi:[0,1,0]
    v_pk_fma_f32 v[130:131], v[34:35], v[58:59], v[50:51] op_sel_hi:[1,0,1] neg_lo:[0,1,0] neg_hi:[0,1,0]
    v_pk_fma_f32 v[132:133], v[36:37], v[58:59], v[52:53] op_sel_hi:[1,0,1] neg_lo:[0,1,0] neg_hi:[0,1,0]
    v_pk_fma_f32 v[134:135], v[38:39], v[58:59], v[54:55] op_sel_hi:[1,0,1] neg_lo:[0,1,0] neg_hi:[0,1,0]
    ds_read_b128 v[32:35], v22 offset:30912
    ds_read_b128 v[48:51], v22 offset:31424
    ds_read_b128 v[36:39], v22 offset:30944
    ds_read_b128 v[52:55], v22 offset:31456
    v_pk_fma_f32 v[128:129], v[88:89], v[10:11], v[128:129] op_sel_hi:[1,0,1]
    v_pk_fma_f32 v[130:131], v[90:91], v[10:11], v[130:131] op_sel_hi:[1,0,1]
    v_pk_fma_f32 v[132:133], v[92:93], v[10:11], v[132:133] op_sel_hi:[1,0,1]
    v_pk_fma_f32 v[134:135], v[94:95], v[10:11], v[134:135] op_sel_hi:[1,0,1]
    v_exp_f32 v136, v128
    v_exp_f32 v137, v129
    v_exp_f32 v138, v130
    v_exp_f32 v139, v131
    v_exp_f32 v140, v132
    v_exp_f32 v141, v133
    v_exp_f32 v142, v134
    v_exp_f32 v143, v135
    v_pk_add_f32 v[136:137], v[136:137], v[12:13]
    v_pk_add_f32 v[138:139], v[138:139], v[12:13]
    v_pk_add_f32 v[140:141], v[140:141], v[12:13]
    v_pk_add_f32 v[142:143], v[142:143], v[12:13]
    v_pk_fma_f32 v[136:137], v[136:137], v[136:137], v[12:13]
    v_pk_fma_f32 v[138:139], v[138:139], v[138:139], v[12:13]
    v_pk_fma_f32 v[140:141], v[140:141], v[140:141], v[12:13]
    v_pk_fma_f32 v[142:143], v[142:143], v[142:143], v[12:13]
    v_rcp_f32 v136, v136
    v_rcp_f32 v137, v137
    v_rcp_f32 v138, v138
    v_rcp_f32 v139, v139
    v_rcp_f32 v140, v140
    v_rcp_f32 v141, v141
    v_rcp_f32 v142, v142
    v_rcp_f32 v143, v143
    v_pk_fma_f32 v[136:137], v[136:137], v[14:15], v[60:61] op_sel_hi:[1,0,0]
    v_pk_fma_f32 v[138:139], v[138:139], v[14:15], v[60:61] op_sel_hi:[1,0,0]
    v_pk_fma_f32 v[140:141], v[140:141], v[14:15], v[60:61] op_sel_hi:[1,0,0]
    v_pk_fma_f32 v[142:143], v[142:143], v[14:15], v[60:61] op_sel_hi:[1,0,0]
    v_pk_mul_f32 v[128:129], v[128:129], v[136:137]
    v_pk_mul_f32 v[130:131], v[130:131], v[138:139]
    v_pk_mul_f32 v[132:133], v[132:133], v[140:141]
    v_pk_mul_f32 v[134:135], v[134:135], v[142:143]
    v_cvt_pk_bf16_f32 v148, v128, v129
    v_cvt_pk_bf16_f32 v149, v130, v131
    v_cvt_pk_bf16_f32 v150, v132, v133
    v_cvt_pk_bf16_f32 v151, v134, v135
    buffer_store_dwordx4 v[148:151], v1, s[44:47], s69 offen offset:1024 sc1
    s_waitcnt lgkmcnt(4)
.p2align 3
    v_pk_fma_f32 v[128:129], v[24:25], v[56:57], v[40:41] op_sel_hi:[1,0,1] neg_lo:[0,1,0] neg_hi:[0,1,0]
    v_pk_fma_f32 v[130:131], v[26:27], v[56:57], v[42:43] op_sel_hi:[1,0,1] neg_lo:[0,1,0] neg_hi:[0,1,0]
    v_pk_fma_f32 v[132:133], v[28:29], v[56:57], v[44:45] op_sel_hi:[1,0,1] neg_lo:[0,1,0] neg_hi:[0,1,0]
    v_pk_fma_f32 v[134:135], v[30:31], v[56:57], v[46:47] op_sel_hi:[1,0,1] neg_lo:[0,1,0] neg_hi:[0,1,0]
    v_pk_fma_f32 v[128:129], v[96:97], v[8:9], v[128:129] op_sel_hi:[1,0,1]
    v_pk_fma_f32 v[130:131], v[98:99], v[8:9], v[130:131] op_sel_hi:[1,0,1]
    v_pk_fma_f32 v[132:133], v[100:101], v[8:9], v[132:133] op_sel_hi:[1,0,1]
    v_pk_fma_f32 v[134:135], v[102:103], v[8:9], v[134:135] op_sel_hi:[1,0,1]
    v_exp_f32 v136, v128
    v_exp_f32 v137, v129
    v_exp_f32 v138, v130
    v_exp_f32 v139, v131
    v_exp_f32 v140, v132
    v_exp_f32 v141, v133
    v_exp_f32 v142, v134
    v_exp_f32 v143, v135
    v_pk_add_f32 v[136:137], v[136:137], v[12:13]
    v_pk_add_f32 v[138:139], v[138:139], v[12:13]
    v_pk_add_f32 v[140:141], v[140:141], v[12:13]
    v_pk_add_f32 v[142:143], v[142:143], v[12:13]
    v_pk_fma_f32 v[136:137], v[136:137], v[136:137], v[12:13]
    v_pk_fma_f32 v[138:139], v[138:139], v[138:139], v[12:13]
    v_pk_fma_f32 v[140:141], v[140:141], v[140:141], v[12:13]
    v_pk_fma_f32 v[142:143], v[142:143], v[142:143], v[12:13]
    v_rcp_f32 v136, v136
    v_rcp_f32 v137, v137
    v_rcp_f32 v138, v138
    v_rcp_f32 v139, v139
    v_rcp_f32 v140, v140
    v_rcp_f32 v141, v141
    v_rcp_f32 v142, v142
    v_rcp_f32 v143, v143
    v_pk_fma_f32 v[136:137], v[136:137], v[14:15], v[60:61] op_sel_hi:[1,0,0]
    v_pk_fma_f32 v[138:139], v[138:139], v[14:15], v[60:61] op_sel_hi:[1,0,0]
    v_pk_fma_f32 v[140:141], v[140:141], v[14:15], v[60:61] op_sel_hi:[1,0,0]
    v_pk_fma_f32 v[142:143], v[142:143], v[14:15], v[60:61] op_sel_hi:[1,0,0]
    v_pk_mul_f32 v[128:129], v[128:129], v[136:137]
    v_pk_mul_f32 v[130:131], v[130:131], v[138:139]
    v_pk_mul_f32 v[132:133], v[132:133], v[140:141]
    v_pk_mul_f32 v[134:135], v[134:135], v[142:143]
    v_cvt_pk_bf16_f32 v144, v128, v129
    v_cvt_pk_bf16_f32 v145, v130, v131
    v_cvt_pk_bf16_f32 v146, v132, v133
    v_cvt_pk_bf16_f32 v147, v134, v135
    buffer_store_dwordx4 v[144:147], v1, s[44:47], s68 offen offset:2048 sc1
    s_waitcnt lgkmcnt(0)
    s_nop 0
    v_pk_fma_f32 v[128:129], v[32:33], v[56:57], v[48:49] op_sel_hi:[1,0,1] neg_lo:[0,1,0] neg_hi:[0,1,0]
    v_pk_fma_f32 v[130:131], v[34:35], v[56:57], v[50:51] op_sel_hi:[1,0,1] neg_lo:[0,1,0] neg_hi:[0,1,0]
    v_pk_fma_f32 v[132:133], v[36:37], v[56:57], v[52:53] op_sel_hi:[1,0,1] neg_lo:[0,1,0] neg_hi:[0,1,0]
    v_pk_fma_f32 v[134:135], v[38:39], v[56:57], v[54:55] op_sel_hi:[1,0,1] neg_lo:[0,1,0] neg_hi:[0,1,0]
    v_pk_fma_f32 v[128:129], v[104:105], v[8:9], v[128:129] op_sel_hi:[1,0,1]
    v_pk_fma_f32 v[130:131], v[106:107], v[8:9], v[130:131] op_sel_hi:[1,0,1]
    v_pk_fma_f32 v[132:133], v[108:109], v[8:9], v[132:133] op_sel_hi:[1,0,1]
    v_pk_fma_f32 v[134:135], v[110:111], v[8:9], v[134:135] op_sel_hi:[1,0,1]
    v_exp_f32 v136, v128
    v_exp_f32 v137, v129
    v_exp_f32 v138, v130
    v_exp_f32 v139, v131
    v_exp_f32 v140, v132
    v_exp_f32 v141, v133
    v_exp_f32 v142, v134
    v_exp_f32 v143, v135
    v_pk_add_f32 v[136:137], v[136:137], v[12:13]
    v_pk_add_f32 v[138:139], v[138:139], v[12:13]
    v_pk_add_f32 v[140:141], v[140:141], v[12:13]
    v_pk_add_f32 v[142:143], v[142:143], v[12:13]
    v_pk_fma_f32 v[136:137], v[136:137], v[136:137], v[12:13]
    v_pk_fma_f32 v[138:139], v[138:139], v[138:139], v[12:13]
    v_pk_fma_f32 v[140:141], v[140:141], v[140:141], v[12:13]
    v_pk_fma_f32 v[142:143], v[142:143], v[142:143], v[12:13]
    v_rcp_f32 v136, v136
    v_rcp_f32 v137, v137
    v_rcp_f32 v138, v138
    v_rcp_f32 v139, v139
    v_rcp_f32 v140, v140
    v_rcp_f32 v141, v141
    v_rcp_f32 v142, v142
    v_rcp_f32 v143, v143
    v_pk_fma_f32 v[136:137], v[136:137], v[14:15], v[60:61] op_sel_hi:[1,0,0]
    v_pk_fma_f32 v[138:139], v[138:139], v[14:15], v[60:61] op_sel_hi:[1,0,0]
    v_pk_fma_f32 v[140:141], v[140:141], v[14:15], v[60:61] op_sel_hi:[1,0,0]
    v_pk_fma_f32 v[142:143], v[142:143], v[14:15], v[60:61] op_sel_hi:[1,0,0]
    v_pk_mul_f32 v[128:129], v[128:129], v[136:137]
    v_pk_mul_f32 v[130:131], v[130:131], v[138:139]
    v_pk_mul_f32 v[132:133], v[132:133], v[140:141]
    v_pk_mul_f32 v[134:135], v[134:135], v[142:143]
    v_cvt_pk_bf16_f32 v148, v128, v129
    v_cvt_pk_bf16_f32 v149, v130, v131
    v_cvt_pk_bf16_f32 v150, v132, v133
    v_cvt_pk_bf16_f32 v151, v134, v135
    buffer_store_dwordx4 v[148:151], v1, s[44:47], s68 offen offset:3072 sc1
    v_pk_fma_f32 v[128:129], v[24:25], v[58:59], v[40:41] op_sel_hi:[1,0,1] neg_lo:[0,1,0] neg_hi:[0,1,0]
    v_pk_fma_f32 v[130:131], v[26:27], v[58:59], v[42:43] op_sel_hi:[1,0,1] neg_lo:[0,1,0] neg_hi:[0,1,0]
    v_pk_fma_f32 v[132:133], v[28:29], v[58:59], v[44:45] op_sel_hi:[1,0,1] neg_lo:[0,1,0] neg_hi:[0,1,0]
    v_pk_fma_f32 v[134:135], v[30:31], v[58:59], v[46:47] op_sel_hi:[1,0,1] neg_lo:[0,1,0] neg_hi:[0,1,0]
    v_pk_fma_f32 v[128:129], v[112:113], v[10:11], v[128:129] op_sel_hi:[1,0,1]
    v_pk_fma_f32 v[130:131], v[114:115], v[10:11], v[130:131] op_sel_hi:[1,0,1]
    v_pk_fma_f32 v[132:133], v[116:117], v[10:11], v[132:133] op_sel_hi:[1,0,1]
    v_pk_fma_f32 v[134:135], v[118:119], v[10:11], v[134:135] op_sel_hi:[1,0,1]
    v_exp_f32 v136, v128
    v_exp_f32 v137, v129
    v_exp_f32 v138, v130
    v_exp_f32 v139, v131
    v_exp_f32 v140, v132
    v_exp_f32 v141, v133
    v_exp_f32 v142, v134
    v_exp_f32 v143, v135
    v_pk_add_f32 v[136:137], v[136:137], v[12:13]
    v_pk_add_f32 v[138:139], v[138:139], v[12:13]
    v_pk_add_f32 v[140:141], v[140:141], v[12:13]
    v_pk_add_f32 v[142:143], v[142:143], v[12:13]
    v_pk_fma_f32 v[136:137], v[136:137], v[136:137], v[12:13]
    v_pk_fma_f32 v[138:139], v[138:139], v[138:139], v[12:13]
    v_pk_fma_f32 v[140:141], v[140:141], v[140:141], v[12:13]
    v_pk_fma_f32 v[142:143], v[142:143], v[142:143], v[12:13]
    v_rcp_f32 v136, v136
    v_rcp_f32 v137, v137
    v_rcp_f32 v138, v138
    v_rcp_f32 v139, v139
    v_rcp_f32 v140, v140
    v_rcp_f32 v141, v141
    v_rcp_f32 v142, v142
    v_rcp_f32 v143, v143
    v_pk_fma_f32 v[136:137], v[136:137], v[14:15], v[60:61] op_sel_hi:[1,0,0]
    v_pk_fma_f32 v[138:139], v[138:139], v[14:15], v[60:61] op_sel_hi:[1,0,0]
    v_pk_fma_f32 v[140:141], v[140:141], v[14:15], v[60:61] op_sel_hi:[1,0,0]
    v_pk_fma_f32 v[142:143], v[142:143], v[14:15], v[60:61] op_sel_hi:[1,0,0]
    v_pk_mul_f32 v[128:129], v[128:129], v[136:137]
    v_pk_mul_f32 v[130:131], v[130:131], v[138:139]
    v_pk_mul_f32 v[132:133], v[132:133], v[140:141]
    v_pk_mul_f32 v[134:135], v[134:135], v[142:143]
    v_cvt_pk_bf16_f32 v144, v128, v129
    v_cvt_pk_bf16_f32 v145, v130, v131
    v_cvt_pk_bf16_f32 v146, v132, v133
    v_cvt_pk_bf16_f32 v147, v134, v135
    buffer_store_dwordx4 v[144:147], v1, s[44:47], s69 offen offset:2048 sc1
    v_pk_fma_f32 v[128:129], v[32:33], v[58:59], v[48:49] op_sel_hi:[1,0,1] neg_lo:[0,1,0] neg_hi:[0,1,0]
    v_pk_fma_f32 v[130:131], v[34:35], v[58:59], v[50:51] op_sel_hi:[1,0,1] neg_lo:[0,1,0] neg_hi:[0,1,0]
    v_pk_fma_f32 v[132:133], v[36:37], v[58:59], v[52:53] op_sel_hi:[1,0,1] neg_lo:[0,1,0] neg_hi:[0,1,0]
    v_pk_fma_f32 v[134:135], v[38:39], v[58:59], v[54:55] op_sel_hi:[1,0,1] neg_lo:[0,1,0] neg_hi:[0,1,0]
    v_pk_fma_f32 v[128:129], v[120:121], v[10:11], v[128:129] op_sel_hi:[1,0,1]
    v_pk_fma_f32 v[130:131], v[122:123], v[10:11], v[130:131] op_sel_hi:[1,0,1]
    v_pk_fma_f32 v[132:133], v[124:125], v[10:11], v[132:133] op_sel_hi:[1,0,1]
    v_pk_fma_f32 v[134:135], v[126:127], v[10:11], v[134:135] op_sel_hi:[1,0,1]
    v_exp_f32 v136, v128
    v_exp_f32 v137, v129
    v_exp_f32 v138, v130
    v_exp_f32 v139, v131
    v_exp_f32 v140, v132
    v_exp_f32 v141, v133
    v_exp_f32 v142, v134
    v_exp_f32 v143, v135
    v_pk_add_f32 v[136:137], v[136:137], v[12:13]
    v_pk_add_f32 v[138:139], v[138:139], v[12:13]
    v_pk_add_f32 v[140:141], v[140:141], v[12:13]
    v_pk_add_f32 v[142:143], v[142:143], v[12:13]
    v_pk_fma_f32 v[136:137], v[136:137], v[136:137], v[12:13]
    v_pk_fma_f32 v[138:139], v[138:139], v[138:139], v[12:13]
    v_pk_fma_f32 v[140:141], v[140:141], v[140:141], v[12:13]
    v_pk_fma_f32 v[142:143], v[142:143], v[142:143], v[12:13]
    v_rcp_f32 v136, v136
    v_rcp_f32 v137, v137
    v_rcp_f32 v138, v138
    v_rcp_f32 v139, v139
    v_rcp_f32 v140, v140
    v_rcp_f32 v141, v141
    v_rcp_f32 v142, v142
    v_rcp_f32 v143, v143
    v_pk_fma_f32 v[136:137], v[136:137], v[14:15], v[60:61] op_sel_hi:[1,0,0]
    v_pk_fma_f32 v[138:139], v[138:139], v[14:15], v[60:61] op_sel_hi:[1,0,0]
    v_pk_fma_f32 v[140:141], v[140:141], v[14:15], v[60:61] op_sel_hi:[1,0,0]
    v_pk_fma_f32 v[142:143], v[142:143], v[14:15], v[60:61] op_sel_hi:[1,0,0]
    v_pk_mul_f32 v[128:129], v[128:129], v[136:137]
    v_pk_mul_f32 v[130:131], v[130:131], v[138:139]
    v_pk_mul_f32 v[132:133], v[132:133], v[140:141]
    v_pk_mul_f32 v[134:135], v[134:135], v[142:143]
    v_cvt_pk_bf16_f32 v148, v128, v129
    v_cvt_pk_bf16_f32 v149, v130, v131
    v_cvt_pk_bf16_f32 v150, v132, v133
    v_cvt_pk_bf16_f32 v151, v134, v135
    s_waitcnt vmcnt(3)
    s_mov_b64 exec, 1
    buffer_store_dword v166, v165, s[44:47], s73 offen
    s_mov_b64 exec, -1
    s_nop 0
    buffer_store_dwordx4 v[148:151], v1, s[44:47], s69 offen offset:3072 sc1
    s_setprio 3
    v_mov_b32 v162, 1
    s_mov_b64 exec, 1
    ds_write_b32 v161, v162 offset:31808
    s_mov_b64 exec, -1
    v_mov_b32 v159, v62
    s_branch L_G2
L_Mhelper:
    s_waitcnt lgkmcnt(0)
    s_barrier
    v_mov_b32 v162, 1
    s_mov_b64 exec, 1
    ds_write_b32 v161, v162 offset:31808
    s_mov_b64 exec, -1
    s_lshl_b32 s74, s2, 7
    s_add_u32 s74, s74, 327680
    s_mov_b32 s73, s74
    v_mov_b32 v159, s74
    s_mov_b32 s79, 400000
L_lw32:
    ds_read_b32 v162, v160 offset:31744
    s_waitcnt lgkmcnt(0)
    v_cmp_gt_u32 vcc, 12, v162
    s_sub_u32 s79, s79, 1
    s_cbranch_scc1 L_lwd32
    s_cbranch_vccz L_lwd32
    s_sleep 8
    s_branch L_lw32
L_lwd32:
    s_sleep 8
    s_setprio 3
    s_load_dword s63, s[32:33], 0
    s_waitcnt lgkmcnt(0)
    s_cmp_lg_u32 s63, 0
    s_cbranch_scc1 L_tf33
    v_mov_b32 v61, 0
    s_mov_b64 exec, 1
    s_mov_b32 s79, 100000
L_poll34:
    buffer_load_dword v62, v61, s[56:59], 0 offen sc1
    s_waitcnt vmcnt(0)
    v_cmp_eq_u32 vcc, 0, v62
    s_sub_u32 s79, s79, 1
    s_cbranch_scc1 L_polled34
    s_cmp_eq_u64 vcc, 0
    s_cbranch_scc1 L_polled34
    s_sleep 8
    s_branch L_poll34
L_polled34:
    s_mov_b64 exec, -1
    v_readfirstlane_b32 s63, v62
    s_nop 1
L_tf33:
L_G2:
    s_lshl_b32 s68, s40, 1
    s_add_u32 s68, s68, s67
    s_lshl_b32 s70, s68, 15
    s_lshl_b32 s69, s41, 7
    s_add_u32 s70, s70, s69
    s_lshl_b32 s69, s66, 6
    s_add_u32 s70, s70, s69
    v_lshlrev_b32 v4, 10, v20
    v_lshl_add_u32 v4, v19, 4, v4
    s_lshl_b32 s69, s67, 12
    s_add_u32 s69, s69, 32768
    v_lshlrev_b32 v5, 7, v20
    v_lshl_add_u32 v5, v19, 3, v5
    v_add_u32 v5, s69, v5
    s_lshl_b32 s69, s66, 2
    v_bfe_u32 v21, v0, 1, 3
    v_xor_b32 v21, s69, v21
    v_lshl_add_u32 v5, v21, 4, v5
    v_lshl_add_u32 v21, v19, 2, v16
    v_lshlrev_b32 v21, 7, v21
    v_lshl_add_u32 v21, v18, 5, v21
    v_lshl_add_u32 v21, v17, 3, v21
    v_lshrrev_b32 v22, 1, v16
    v_xor_b32 v23, s67, v22
    v_lshl_add_u32 v6, v23, 6, v21
    s_lshl_b32 s69, s66, 12
    s_add_u32 s69, s69, 16384
    v_add_u32 v6, s69, v6
    s_lshl_b32 s69, s66, 14
    s_add_u32 s69, s69, 65536
    v_add_u32 v21, s69, v21
    v_xor_b32 v22, s66, v22
    v_lshl_add_u32 v2, v22, 6, v21
    v_xor_b32 v22, 1, v22
    v_lshl_add_u32 v3, v22, 6, v21
    v_add_u32 v7, 4096, v1
    s_mul_i32 s68, s68, 112
    s_mul_i32 s69, s66, 56
    s_add_u32 s68, s68, s69
    s_lshl_b32 s68, s68, 10
    s_add_u32 s68, s68, 5767168
    s_mov_b32 s71, s7
    s_lshl_b32 s75, s40, 1
    s_add_u32 s75, s75, s66
    s_mul_i32 s75, s75, 896
    s_add_u32 s75, s75, 262144
    v_mov_b32 v165, 0
    v_mov_b32 v166, s63
    buffer_load_dword v167, v164, s[44:47], 0 offen nt
    ds_read_b32 v162, v160 offset:31744
    s_waitcnt lgkmcnt(0)
    v_cmp_gt_u32 vcc, 9, v162
    s_nop 0
    s_cbranch_vccz L_f9
    s_waitcnt vmcnt(0)
    s_mov_b64 exec, 1
    buffer_store_dword v166, v165, s[44:47], s73 offen offset:64
    s_mov_b64 exec, -1
    s_mov_b32 s79, 400000
L_lw35:
    ds_read_b32 v162, v160 offset:31744
    s_waitcnt lgkmcnt(0)
    v_cmp_gt_u32 vcc, 9, v162
    s_sub_u32 s79, s79, 1
    s_cbranch_scc1 L_lwd35
    s_cbranch_vccz L_lwd35
    s_sleep 1
    s_branch L_lw35
L_lwd35:
L_f9:
    ds_read_b64_tr_b16 v[40:41], v2 offset:0
    ds_read_b64_tr_b16 v[42:43], v2 offset:1024
    ds_read_b64_tr_b16 v[44:45], v3 offset:0
    ds_read_b64_tr_b16 v[46:47], v3 offset:1024
    ds_read_b64_tr_b16 v[48:49], v2 offset:2048
    ds_read_b64_tr_b16 v[50:51], v2 offset:3072
    ds_read_b64_tr_b16 v[52:53], v3 offset:2048
    ds_read_b64_tr_b16 v[54:55], v3 offset:3072
    ds_read_b64_tr_b16 v[56:57], v2 offset:4096
    ds_read_b64_tr_b16 v[58:59], v2 offset:5120
    ds_read_b64_tr_b16 v[60:61], v3 offset:4096
    ds_read_b64_tr_b16 v[62:63], v3 offset:5120
    ds_read_b64_tr_b16 v[64:65], v2 offset:6144
    ds_read_b64_tr_b16 v[66:67], v2 offset:7168
    ds_read_b64_tr_b16 v[68:69], v3 offset:6144
    ds_read_b64_tr_b16 v[70:71], v3 offset:7168
    ds_read_b64_tr_b16 v[72:73], v2 offset:8192
    ds_read_b64_tr_b16 v[74:75], v2 offset:9216
    ds_read_b64_tr_b16 v[76:77], v3 offset:8192
    ds_read_b64_tr_b16 v[78:79], v3 offset:9216
    ds_read_b64_tr_b16 v[80:81], v2 offset:10240
    ds_read_b64_tr_b16 v[82:83], v2 offset:11264
    ds_read_b64_tr_b16 v[84:85], v3 offset:10240
    ds_read_b64_tr_b16 v[86:87], v3 offset:11264
    ds_read_b64_tr_b16 v[88:89], v2 offset:12288
    ds_read_b64_tr_b16 v[90:91], v2 offset:13312
    ds_read_b64_tr_b16 v[92:93], v3 offset:12288
    ds_read_b64_tr_b16 v[94:95], v3 offset:13312
    ds_read_b64_tr_b16 v[96:97], v2 offset:14336
    ds_read_b64_tr_b16 v[98:99], v2 offset:15360
    ds_read_b64_tr_b16 v[100:101], v3 offset:14336
    ds_read_b64_tr_b16 v[102:103], v3 offset:15360
    v_mov_b32 v163, 9
    s_mov_b64 exec, 1
    ds_write_b32 v161, v163 offset:31760
    s_mov_b64 exec, -1
    s_add_u32 s60, s34, s75
    s_addc_u32 s61, s35, 0
    s_waitcnt vmcnt(0)
    s_mov_b64 exec, 1
    buffer_store_dword v166, v165, s[44:47], s73 offen offset:64
    s_mov_b64 exec, 0x3fff
    v_cmp_ne_u32 vcc, s63, v167
    s_mov_b64 exec, -1
    s_cbranch_vccz L_aok
    s_mov_b32 s79, 100000
    s_mov_b64 exec, 0x3fff
L_aqa:
    s_mov_b32 s62, 16
L_aq1a:
    buffer_load_dword v167, v164, s[44:47], 0 offen offset:0 nt
    s_waitcnt vmcnt(0)
    v_cmp_ne_u32 vcc, s63, v167
    s_sub_u32 s62, s62, 1
    s_cbranch_vccz L_aqda
    s_sleep 2
    s_cmp_lg_u32 s62, 0
    s_cbranch_scc1 L_aq1a
    buffer_store_dword v166, v165, s[44:47], s74 offen sc1
    s_load_dwordx2 s[8:9], s[60:61], 0 glc
    s_load_dwordx2 s[10:11], s[60:61], 128 glc
    s_load_dwordx2 s[12:13], s[60:61], 256 glc
    s_load_dwordx2 s[14:15], s[60:61], 384 glc
    s_load_dwordx2 s[16:17], s[60:61], 512 glc
    s_load_dwordx2 s[18:19], s[60:61], 640 glc
    s_load_dwordx2 s[20:21], s[60:61], 768 glc
    s_waitcnt lgkmcnt(0)
    s_xor_b32 s8, s8, s63
    s_or_b32 s62, s62, s8
    s_xor_b32 s9, s9, s63
    s_or_b32 s62, s62, s9
    s_xor_b32 s10, s10, s63
    s_or_b32 s62, s62, s10
    s_xor_b32 s11, s11, s63
    s_or_b32 s62, s62, s11
    s_xor_b32 s12, s12, s63
    s_or_b32 s62, s62, s12
    s_xor_b32 s13, s13, s63
    s_or_b32 s62, s62, s13
    s_xor_b32 s14, s14, s63
    s_or_b32 s62, s62, s14
    s_xor_b32 s15, s15, s63
    s_or_b32 s62, s62, s15
    s_xor_b32 s16, s16, s63
    s_or_b32 s62, s62, s16
    s_xor_b32 s17, s17, s63
    s_or_b32 s62, s62, s17
    s_xor_b32 s18, s18, s63
    s_or_b32 s62, s62, s18
    s_xor_b32 s19, s19, s63
    s_or_b32 s62, s62, s19
    s_xor_b32 s20, s20, s63
    s_or_b32 s62, s62, s20
    s_xor_b32 s21, s21, s63
    s_or_b32 s62, s62, s21
    s_cbranch_scc0 L_aqda
    s_sub_u32 s79, s79, 1
    s_cbranch_scc0 L_aqa
L_aqda:
    s_mov_b64 exec, -1
L_aok:
    s_waitcnt lgkmcnt(0)
    s_add_u32 s72, s68, 0
    buffer_load_dwordx4 v[104:107], v1, s[44:47], s72 offen offset:0 sc1
    buffer_load_dwordx4 v[108:111], v1, s[44:47], s72 offen offset:1024 sc1
    buffer_load_dwordx4 v[112:115], v7, s[44:47], s72 offen offset:0 sc1
    buffer_load_dwordx4 v[116:119], v7, s[44:47], s72 offen offset:1024 sc1
    s_add_u32 s72, s68, 8192
    buffer_load_dwordx4 v[120:123], v1, s[44:47], s72 offen offset:0 sc1
    buffer_load_dwordx4 v[124:127], v1, s[44:47], s72 offen offset:1024 sc1
    buffer_load_dwordx4 v[128:131], v7, s[44:47], s72 offen offset:0 sc1
    buffer_load_dwordx4 v[132:135], v7, s[44:47], s72 offen offset:1024 sc1
    s_add_u32 s72, s68, 16384
    buffer_load_dwordx4 v[136:139], v1, s[44:47], s72 offen offset:0 sc1
    s_mov_b64 exec, 1
    buffer_store_dword v166, v165, s[44:47], s74 offen sc1
    s_mov_b64 exec, -1
    s_setprio 1
    ds_read_b32 v162, v160 offset:31744
    s_waitcnt vmcnt(9)
    v_mfma_f32_32x32x16_bf16 v[8:23], v[40:43], v[104:107], 0
    v_mfma_f32_32x32x16_bf16 v[24:39], v[44:47], v[104:107], 0
    buffer_load_dwordx4 v[140:143], v1, s[44:47], s72 offen offset:1024 sc1
    buffer_load_dwordx4 v[144:147], v7, s[44:47], s72 offen offset:0 sc1
    s_waitcnt vmcnt(10) lgkmcnt(0)
    v_cmp_gt_u32 vcc, 10, v162
    v_mfma_f32_32x32x16_bf16 v[8:23], v[48:51], v[108:111], v[8:23]
    v_add_u32 v2, 0x00008000, v2
    v_add_u32 v3, 0x00008000, v3
    s_cbranch_vccnz L_g2slow9
L_g2go9:
    ds_read_b64_tr_b16 v[40:41], v2 offset:0
    ds_read_b64_tr_b16 v[42:43], v2 offset:1024
    v_mfma_f32_32x32x16_bf16 v[24:39], v[52:55], v[108:111], v[24:39]
    ds_read_b64_tr_b16 v[44:45], v3 offset:0
    ds_read_b64_tr_b16 v[46:47], v3 offset:1024
    buffer_load_dwordx4 v[104:107], v7, s[44:47], s72 offen offset:1024 sc1
    s_waitcnt vmcnt(10)
    v_mfma_f32_32x32x16_bf16 v[8:23], v[56:59], v[112:115], v[8:23]
    ds_read_b64_tr_b16 v[48:49], v2 offset:2048
    ds_read_b64_tr_b16 v[50:51], v2 offset:3072
    v_mfma_f32_32x32x16_bf16 v[24:39], v[60:63], v[112:115], v[24:39]
    ds_read_b64_tr_b16 v[52:53], v3 offset:2048
    ds_read_b64_tr_b16 v[54:55], v3 offset:3072
    s_add_u32 s72, s68, 24576
    buffer_load_dwordx4 v[108:111], v1, s[44:47], s72 offen offset:0 sc1
    s_waitcnt vmcnt(10)
    v_mfma_f32_32x32x16_bf16 v[8:23], v[64:67], v[116:119], v[8:23]
    ds_read_b64_tr_b16 v[56:57], v2 offset:4096
    ds_read_b64_tr_b16 v[58:59], v2 offset:5120
    v_mfma_f32_32x32x16_bf16 v[24:39], v[68:71], v[116:119], v[24:39]
    ds_read_b64_tr_b16 v[60:61], v3 offset:4096
    ds_read_b64_tr_b16 v[62:63], v3 offset:5120
    buffer_load_dwordx4 v[112:115], v1, s[44:47], s72 offen offset:1024 sc1
    s_waitcnt vmcnt(10)
    v_mfma_f32_32x32x16_bf16 v[8:23], v[72:75], v[120:123], v[8:23]
    ds_read_b64_tr_b16 v[64:65], v2 offset:6144
    ds_read_b64_tr_b16 v[66:67], v2 offset:7168
    v_mfma_f32_32x32x16_bf16 v[24:39], v[76:79], v[120:123], v[24:39]
    ds_read_b64_tr_b16 v[68:69], v3 offset:6144
    ds_read_b64_tr_b16 v[70:71], v3 offset:7168
    buffer_load_dwordx4 v[116:119], v7, s[44:47], s72 offen offset:0 sc1
    s_waitcnt vmcnt(10)
    v_mfma_f32_32x32x16_bf16 v[8:23], v[80:83], v[124:127], v[8:23]
    ds_read_b64_tr_b16 v[72:73], v2 offset:8192
    ds_read_b64_tr_b16 v[74:75], v2 offset:9216
    v_mfma_f32_32x32x16_bf16 v[24:39], v[84:87], v[124:127], v[24:39]
    ds_read_b64_tr_b16 v[76:77], v3 offset:8192
    ds_read_b64_tr_b16 v[78:79], v3 offset:9216
    ds_read_b32 v162, v160 offset:31744
    buffer_load_dwordx4 v[120:123], v7, s[44:47], s72 offen offset:1024 sc1
    s_waitcnt vmcnt(10)
    v_mfma_f32_32x32x16_bf16 v[8:23], v[88:91], v[128:131], v[8:23]
    ds_read_b64_tr_b16 v[80:81], v2 offset:10240
    ds_read_b64_tr_b16 v[82:83], v2 offset:11264
    v_mfma_f32_32x32x16_bf16 v[24:39], v[92:95], v[128:131], v[24:39]
    ds_read_b64_tr_b16 v[84:85], v3 offset:10240
    ds_read_b64_tr_b16 v[86:87], v3 offset:11264
    s_add_u32 s72, s68, 32768
    buffer_load_dwordx4 v[124:127], v1, s[44:47], s72 offen offset:0 sc1
    s_waitcnt vmcnt(10)
    v_mfma_f32_32x32x16_bf16 v[8:23], v[96:99], v[132:135], v[8:23]
    ds_read_b64_tr_b16 v[88:89], v2 offset:12288
    ds_read_b64_tr_b16 v[90:91], v2 offset:13312
    v_mfma_f32_32x32x16_bf16 v[24:39], v[100:103], v[132:135], v[24:39]
    ds_read_b64_tr_b16 v[92:93], v3 offset:12288
    ds_read_b64_tr_b16 v[94:95], v3 offset:13312
    buffer_load_dwordx4 v[128:131], v1, s[44:47], s72 offen offset:1024 sc1
    buffer_load_dword v167, v164, s[44:47], 0 offen offset:64 nt
    s_waitcnt vmcnt(11) lgkmcnt(14)
    v_mfma_f32_32x32x16_bf16 v[8:23], v[40:43], v[136:139], v[8:23]
    s_setprio 3
    ds_read_b64_tr_b16 v[96:97], v2 offset:14336
    ds_read_b64_tr_b16 v[98:99], v2 offset:15360
    v_mov_b32 v163, 10
    v_mfma_f32_32x32x16_bf16 v[24:39], v[44:47], v[136:139], v[24:39]
    ds_read_b64_tr_b16 v[100:101], v3 offset:14336
    ds_read_b64_tr_b16 v[102:103], v3 offset:15360
    s_mov_b64 exec, 1
    ds_write_b32 v161, v163 offset:31760
    s_mov_b64 exec, -1
    buffer_load_dwordx4 v[132:135], v7, s[44:47], s72 offen offset:0 sc1
    s_waitcnt vmcnt(10) lgkmcnt(13)
    v_cmp_gt_u32 vcc, 11, v162
    v_mfma_f32_32x32x16_bf16 v[8:23], v[48:51], v[140:143], v[8:23]
    v_add_u32 v2, 0x00008000, v2
    v_add_u32 v3, 0x00008000, v3
    s_cbranch_vccnz L_g2slow10
L_g2go10:
    ds_read_b64_tr_b16 v[40:41], v2 offset:0
    ds_read_b64_tr_b16 v[42:43], v2 offset:1024
    v_mfma_f32_32x32x16_bf16 v[24:39], v[52:55], v[140:143], v[24:39]
    ds_read_b64_tr_b16 v[44:45], v3 offset:0
    ds_read_b64_tr_b16 v[46:47], v3 offset:1024
    buffer_load_dwordx4 v[136:139], v7, s[44:47], s72 offen offset:1024 sc1
    s_waitcnt vmcnt(10)
    v_mfma_f32_32x32x16_bf16 v[8:23], v[56:59], v[144:147], v[8:23]
    ds_read_b64_tr_b16 v[48:49], v2 offset:2048
    ds_read_b64_tr_b16 v[50:51], v2 offset:3072
    v_mfma_f32_32x32x16_bf16 v[24:39], v[60:63], v[144:147], v[24:39]
    ds_read_b64_tr_b16 v[52:53], v3 offset:2048
    ds_read_b64_tr_b16 v[54:55], v3 offset:3072
    s_add_u32 s72, s68, 40960
    buffer_load_dwordx4 v[140:143], v1, s[44:47], s72 offen offset:0 sc1
    s_waitcnt vmcnt(10)
    v_mfma_f32_32x32x16_bf16 v[8:23], v[64:67], v[104:107], v[8:23]
    ds_read_b64_tr_b16 v[56:57], v2 offset:4096
    ds_read_b64_tr_b16 v[58:59], v2 offset:5120
    v_mfma_f32_32x32x16_bf16 v[24:39], v[68:71], v[104:107], v[24:39]
    ds_read_b64_tr_b16 v[60:61], v3 offset:4096
    ds_read_b64_tr_b16 v[62:63], v3 offset:5120
    buffer_load_dwordx4 v[144:147], v1, s[44:47], s72 offen offset:1024 sc1
    s_waitcnt vmcnt(10)
    v_mfma_f32_32x32x16_bf16 v[8:23], v[72:75], v[108:111], v[8:23]
    ds_read_b64_tr_b16 v[64:65], v2 offset:6144
    ds_read_b64_tr_b16 v[66:67], v2 offset:7168
    v_mfma_f32_32x32x16_bf16 v[24:39], v[76:79], v[108:111], v[24:39]
    ds_read_b64_tr_b16 v[68:69], v3 offset:6144
    ds_read_b64_tr_b16 v[70:71], v3 offset:7168
    buffer_load_dwordx4 v[104:107], v7, s[44:47], s72 offen offset:0 sc1
    s_waitcnt vmcnt(10) lgkmcnt(14)
    v_mfma_f32_32x32x16_bf16 v[8:23], v[80:83], v[112:115], v[8:23]
    ds_read_b64_tr_b16 v[72:73], v2 offset:8192
    ds_read_b64_tr_b16 v[74:75], v2 offset:9216
    v_mfma_f32_32x32x16_bf16 v[24:39], v[84:87], v[112:115], v[24:39]
    ds_read_b64_tr_b16 v[76:77], v3 offset:8192
    ds_read_b64_tr_b16 v[78:79], v3 offset:9216
    ds_read_b32 v162, v160 offset:31744
    buffer_load_dwordx4 v[108:111], v7, s[44:47], s72 offen offset:1024 sc1
    s_waitcnt vmcnt(10)
    v_mfma_f32_32x32x16_bf16 v[8:23], v[88:91], v[116:119], v[8:23]
    ds_read_b64_tr_b16 v[80:81], v2 offset:10240
    ds_read_b64_tr_b16 v[82:83], v2 offset:11264
    v_mfma_f32_32x32x16_bf16 v[24:39], v[92:95], v[116:119], v[24:39]
    ds_read_b64_tr_b16 v[84:85], v3 offset:10240
    ds_read_b64_tr_b16 v[86:87], v3 offset:11264
    s_add_u32 s72, s68, 49152
    buffer_load_dwordx4 v[112:115], v1, s[44:47], s72 offen offset:0 sc1
    s_waitcnt vmcnt(10)
    v_mfma_f32_32x32x16_bf16 v[8:23], v[96:99], v[120:123], v[8:23]
    ds_read_b64_tr_b16 v[88:89], v2 offset:12288
    ds_read_b64_tr_b16 v[90:91], v2 offset:13312
    v_mfma_f32_32x32x16_bf16 v[24:39], v[100:103], v[120:123], v[24:39]
    ds_read_b64_tr_b16 v[92:93], v3 offset:12288
    ds_read_b64_tr_b16 v[94:95], v3 offset:13312
    buffer_load_dwordx4 v[116:119], v1, s[44:47], s72 offen offset:1024 sc1
    s_waitcnt vmcnt(10) lgkmcnt(14)
    v_mfma_f32_32x32x16_bf16 v[8:23], v[40:43], v[124:127], v[8:23]
    ds_read_b64_tr_b16 v[96:97], v2 offset:14336
    ds_read_b64_tr_b16 v[98:99], v2 offset:15360
    v_mov_b32 v163, 11
    v_mfma_f32_32x32x16_bf16 v[24:39], v[44:47], v[124:127], v[24:39]
    ds_read_b64_tr_b16 v[100:101], v3 offset:14336
    ds_read_b64_tr_b16 v[102:103], v3 offset:15360
    s_mov_b64 exec, 1
    ds_write_b32 v161, v163 offset:31760
    s_mov_b64 exec, -1
    buffer_load_dwordx4 v[120:123], v7, s[44:47], s72 offen offset:0 sc1
    s_waitcnt vmcnt(10) lgkmcnt(13)
    v_cmp_gt_u32 vcc, 12, v162
    v_mfma_f32_32x32x16_bf16 v[8:23], v[48:51], v[128:131], v[8:23]
    v_add_u32 v2, 0xfffe8000, v2
    v_add_u32 v3, 0xfffe8000, v3
    s_cbranch_vccnz L_g2slow11
L_g2go11:
    ds_read_b64_tr_b16 v[40:41], v2 offset:0
    ds_read_b64_tr_b16 v[42:43], v2 offset:1024
    v_mfma_f32_32x32x16_bf16 v[24:39], v[52:55], v[128:131], v[24:39]
    ds_read_b64_tr_b16 v[44:45], v3 offset:0
    ds_read_b64_tr_b16 v[46:47], v3 offset:1024
    buffer_load_dwordx4 v[124:127], v7, s[44:47], s72 offen offset:1024 sc1
    s_waitcnt vmcnt(9)
    v_mfma_f32_32x32x16_bf16 v[8:23], v[56:59], v[132:135], v[8:23]
    ds_read_b64_tr_b16 v[48:49], v2 offset:2048
    ds_read_b64_tr_b16 v[50:51], v2 offset:3072
    v_mfma_f32_32x32x16_bf16 v[24:39], v[60:63], v[132:135], v[24:39]
    ds_read_b64_tr_b16 v[52:53], v3 offset:2048
    ds_read_b64_tr_b16 v[54:55], v3 offset:3072
    s_add_u32 s72, s68, 2048
    s_waitcnt vmcnt(10)
    s_mov_b64 exec, 0x3fff
    v_cmp_ne_u32 vcc, s63, v167
    s_mov_b64 exec, -1
    s_cbranch_vccnz L_bslow
L_bok:
    buffer_load_dwordx4 v[128:131], v1, s[44:47], s72 offen offset:0 sc1
    s_waitcnt vmcnt(9)
    v_mfma_f32_32x32x16_bf16 v[8:23], v[64:67], v[136:139], v[8:23]
    ds_read_b64_tr_b16 v[56:57], v2 offset:4096
    ds_read_b64_tr_b16 v[58:59], v2 offset:5120
    v_mfma_f32_32x32x16_bf16 v[24:39], v[68:71], v[136:139], v[24:39]
    ds_read_b64_tr_b16 v[60:61], v3 offset:4096
    ds_read_b64_tr_b16 v[62:63], v3 offset:5120
    buffer_load_dwordx4 v[132:135], v1, s[44:47], s72 offen offset:1024 sc1
    s_waitcnt vmcnt(9)
    v_mfma_f32_32x32x16_bf16 v[8:23], v[72:75], v[140:143], v[8:23]
    ds_read_b64_tr_b16 v[64:65], v2 offset:6144
    ds_read_b64_tr_b16 v[66:67], v2 offset:7168
    v_mfma_f32_32x32x16_bf16 v[24:39], v[76:79], v[140:143], v[24:39]
    ds_read_b64_tr_b16 v[68:69], v3 offset:6144
    ds_read_b64_tr_b16 v[70:71], v3 offset:7168
    buffer_load_dwordx4 v[136:139], v7, s[44:47], s72 offen offset:0 sc1
    s_waitcnt vmcnt(9) lgkmcnt(14)
    v_mfma_f32_32x32x16_bf16 v[8:23], v[80:83], v[144:147], v[8:23]
    ds_read_b64_tr_b16 v[72:73], v2 offset:8192
    ds_read_b64_tr_b16 v[74:75], v2 offset:9216
    v_mfma_f32_32x32x16_bf16 v[24:39], v[84:87], v[144:147], v[24:39]
    ds_read_b64_tr_b16 v[76:77], v3 offset:8192
    ds_read_b64_tr_b16 v[78:79], v3 offset:9216
    ds_read_b32 v162, v160 offset:31744
    buffer_load_dwordx4 v[140:143], v7, s[44:47], s72 offen offset:1024 sc1
    s_waitcnt vmcnt(9)
    v_mfma_f32_32x32x16_bf16 v[8:23], v[88:91], v[104:107], v[8:23]
    ds_read_b64_tr_b16 v[80:81], v2 offset:10240
    ds_read_b64_tr_b16 v[82:83], v2 offset:11264
    v_mfma_f32_32x32x16_bf16 v[24:39], v[92:95], v[104:107], v[24:39]
    ds_read_b64_tr_b16 v[84:85], v3 offset:10240
    ds_read_b64_tr_b16 v[86:87], v3 offset:11264
    s_add_u32 s72, s68, 10240
    buffer_load_dwordx4 v[144:147], v1, s[44:47], s72 offen offset:0 sc1
    s_waitcnt vmcnt(9)
    v_mfma_f32_32x32x16_bf16 v[8:23], v[96:99], v[108:111], v[8:23]
    ds_read_b64_tr_b16 v[88:89], v2 offset:12288
    ds_read_b64_tr_b16 v[90:91], v2 offset:13312
    v_mfma_f32_32x32x16_bf16 v[24:39], v[100:103], v[108:111], v[24:39]
    ds_read_b64_tr_b16 v[92:93], v3 offset:12288
    ds_read_b64_tr_b16 v[94:95], v3 offset:13312
    buffer_load_dwordx4 v[104:107], v1, s[44:47], s72 offen offset:1024 sc1
    s_waitcnt vmcnt(9) lgkmcnt(14)
    v_mfma_f32_32x32x16_bf16 v[8:23], v[40:43], v[112:115], v[8:23]
    ds_read_b64_tr_b16 v[96:97], v2 offset:14336
    ds_read_b64_tr_b16 v[98:99], v2 offset:15360
    v_mov_b32 v163, 12
    v_mfma_f32_32x32x16_bf16 v[24:39], v[44:47], v[112:115], v[24:39]
    ds_read_b64_tr_b16 v[100:101], v3 offset:14336
    ds_read_b64_tr_b16 v[102:103], v3 offset:15360
    s_mov_b64 exec, 1
    ds_write_b32 v161, v163 offset:31760
    s_mov_b64 exec, -1
    buffer_load_dwordx4 v[108:111], v7, s[44:47], s72 offen offset:0 sc1
    s_waitcnt vmcnt(9) lgkmcnt(13)
    v_cmp_gt_u32 vcc, 13, v162
    v_mfma_f32_32x32x16_bf16 v[8:23], v[48:51], v[116:119], v[8:23]
    v_add_u32 v2, 0x00008000, v2
    v_add_u32 v3, 0x00008000, v3
    s_cbranch_vccnz L_g2slow12
L_g2go12:
    ds_read_b64_tr_b16 v[40:41], v2 offset:0
    ds_read_b64_tr_b16 v[42:43], v2 offset:1024
    v_mfma_f32_32x32x16_bf16 v[24:39], v[52:55], v[116:119], v[24:39]
    ds_read_b64_tr_b16 v[44:45], v3 offset:0
    ds_read_b64_tr_b16 v[46:47], v3 offset:1024
    buffer_load_dwordx4 v[112:115], v7, s[44:47], s72 offen offset:1024 sc1
    s_waitcnt vmcnt(9)
    v_mfma_f32_32x32x16_bf16 v[8:23], v[56:59], v[120:123], v[8:23]
    ds_read_b64_tr_b16 v[48:49], v2 offset:2048
    ds_read_b64_tr_b16 v[50:51], v2 offset:3072
    v_mfma_f32_32x32x16_bf16 v[24:39], v[60:63], v[120:123], v[24:39]
    ds_read_b64_tr_b16 v[52:53], v3 offset:2048
    ds_read_b64_tr_b16 v[54:55], v3 offset:3072
    s_add_u32 s72, s68, 18432
    buffer_load_dwordx4 v[116:119], v1, s[44:47], s72 offen offset:0 sc1
    s_waitcnt vmcnt(9)
    v_mfma_f32_32x32x16_bf16 v[8:23], v[64:67], v[124:127], v[8:23]
    ds_read_b64_tr_b16 v[56:57], v2 offset:4096
    ds_read_b64_tr_b16 v[58:59], v2 offset:5120
    v_mfma_f32_32x32x16_bf16 v[24:39], v[68:71], v[124:127], v[24:39]
    ds_read_b64_tr_b16 v[60:61], v3 offset:4096
    ds_read_b64_tr_b16 v[62:63], v3 offset:5120
    buffer_load_dwordx4 v[120:123], v1, s[44:47], s72 offen offset:1024 sc1
    s_waitcnt vmcnt(9)
    v_mfma_f32_32x32x16_bf16 v[8:23], v[72:75], v[128:131], v[8:23]
    ds_read_b64_tr_b16 v[64:65], v2 offset:6144
    ds_read_b64_tr_b16 v[66:67], v2 offset:7168
    v_mfma_f32_32x32x16_bf16 v[24:39], v[76:79], v[128:131], v[24:39]
    ds_read_b64_tr_b16 v[68:69], v3 offset:6144
    ds_read_b64_tr_b16 v[70:71], v3 offset:7168
    buffer_load_dwordx4 v[124:127], v7, s[44:47], s72 offen offset:0 sc1
    s_waitcnt vmcnt(9) lgkmcnt(14)
    v_mfma_f32_32x32x16_bf16 v[8:23], v[80:83], v[132:135], v[8:23]
    ds_read_b64_tr_b16 v[72:73], v2 offset:8192
    ds_read_b64_tr_b16 v[74:75], v2 offset:9216
    v_mfma_f32_32x32x16_bf16 v[24:39], v[84:87], v[132:135], v[24:39]
    ds_read_b64_tr_b16 v[76:77], v3 offset:8192
    ds_read_b64_tr_b16 v[78:79], v3 offset:9216
    ds_read_b32 v162, v160 offset:31744
    buffer_load_dwordx4 v[128:131], v7, s[44:47], s72 offen offset:1024 sc1
    s_waitcnt vmcnt(9)
    v_mfma_f32_32x32x16_bf16 v[8:23], v[88:91], v[136:139], v[8:23]
    ds_read_b64_tr_b16 v[80:81], v2 offset:10240
    ds_read_b64_tr_b16 v[82:83], v2 offset:11264
    v_mfma_f32_32x32x16_bf16 v[24:39], v[92:95], v[136:139], v[24:39]
    ds_read_b64_tr_b16 v[84:85], v3 offset:10240
    ds_read_b64_tr_b16 v[86:87], v3 offset:11264
    s_add_u32 s72, s68, 26624
    buffer_load_dwordx4 v[132:135], v1, s[44:47], s72 offen offset:0 sc1
    s_waitcnt vmcnt(9)
    v_mfma_f32_32x32x16_bf16 v[8:23], v[96:99], v[140:143], v[8:23]
    ds_read_b64_tr_b16 v[88:89], v2 offset:12288
    ds_read_b64_tr_b16 v[90:91], v2 offset:13312
    v_mfma_f32_32x32x16_bf16 v[24:39], v[100:103], v[140:143], v[24:39]
    ds_read_b64_tr_b16 v[92:93], v3 offset:12288
    ds_read_b64_tr_b16 v[94:95], v3 offset:13312
    buffer_load_dwordx4 v[136:139], v1, s[44:47], s72 offen offset:1024 sc1
    s_waitcnt vmcnt(9) lgkmcnt(14)
    v_mfma_f32_32x32x16_bf16 v[8:23], v[40:43], v[144:147], v[8:23]
    ds_read_b64_tr_b16 v[96:97], v2 offset:14336
    ds_read_b64_tr_b16 v[98:99], v2 offset:15360
    v_mfma_f32_32x32x16_bf16 v[24:39], v[44:47], v[144:147], v[24:39]
    ds_read_b64_tr_b16 v[100:101], v3 offset:14336
    ds_read_b64_tr_b16 v[102:103], v3 offset:15360
    buffer_load_dwordx4 v[140:143], v7, s[44:47], s72 offen offset:0 sc1
    s_waitcnt vmcnt(9) lgkmcnt(12)
    v_cmp_gt_u32 vcc, 14, v162
    v_mfma_f32_32x32x16_bf16 v[8:23], v[48:51], v[104:107], v[8:23]
    v_add_u32 v2, 0x00008000, v2
    v_add_u32 v3, 0x00008000, v3
    s_cbranch_vccnz L_g2slow13
L_g2go13:
    ds_read_b64_tr_b16 v[40:41], v2 offset:0
    ds_read_b64_tr_b16 v[42:43], v2 offset:1024
    v_mfma_f32_32x32x16_bf16 v[24:39], v[52:55], v[104:107], v[24:39]
    ds_read_b64_tr_b16 v[44:45], v3 offset:0
    ds_read_b64_tr_b16 v[46:47], v3 offset:1024
    buffer_load_dwordx4 v[144:147], v7, s[44:47], s72 offen offset:1024 sc1
    s_waitcnt vmcnt(9)
    v_mfma_f32_32x32x16_bf16 v[8:23], v[56:59], v[108:111], v[8:23]
    ds_read_b64_tr_b16 v[48:49], v2 offset:2048
    ds_read_b64_tr_b16 v[50:51], v2 offset:3072
    v_mfma_f32_32x32x16_bf16 v[24:39], v[60:63], v[108:111], v[24:39]
    ds_read_b64_tr_b16 v[52:53], v3 offset:2048
    ds_read_b64_tr_b16 v[54:55], v3 offset:3072
    s_add_u32 s72, s68, 34816
    buffer_load_dwordx4 v[104:107], v1, s[44:47], s72 offen offset:0 sc1
    s_waitcnt vmcnt(9)
    v_mfma_f32_32x32x16_bf16 v[8:23], v[64:67], v[112:115], v[8:23]
    ds_read_b64_tr_b16 v[56:57], v2 offset:4096
    ds_read_b64_tr_b16 v[58:59], v2 offset:5120
    v_mfma_f32_32x32x16_bf16 v[24:39], v[68:71], v[112:115], v[24:39]
    ds_read_b64_tr_b16 v[60:61], v3 offset:4096
    ds_read_b64_tr_b16 v[62:63], v3 offset:5120
    buffer_load_dwordx4 v[108:111], v1, s[44:47], s72 offen offset:1024 sc1
    s_waitcnt vmcnt(9)
    v_mfma_f32_32x32x16_bf16 v[8:23], v[72:75], v[116:119], v[8:23]
    ds_read_b64_tr_b16 v[64:65], v2 offset:6144
    ds_read_b64_tr_b16 v[66:67], v2 offset:7168
    v_mfma_f32_32x32x16_bf16 v[24:39], v[76:79], v[116:119], v[24:39]
    ds_read_b64_tr_b16 v[68:69], v3 offset:6144
    ds_read_b64_tr_b16 v[70:71], v3 offset:7168
    buffer_load_dwordx4 v[112:115], v7, s[44:47], s72 offen offset:0 sc1
    s_waitcnt vmcnt(9) lgkmcnt(14)
    v_mfma_f32_32x32x16_bf16 v[8:23], v[80:83], v[120:123], v[8:23]
    ds_read_b64_tr_b16 v[72:73], v2 offset:8192
    ds_read_b64_tr_b16 v[74:75], v2 offset:9216
    v_mfma_f32_32x32x16_bf16 v[24:39], v[84:87], v[120:123], v[24:39]
    ds_read_b64_tr_b16 v[76:77], v3 offset:8192
    ds_read_b64_tr_b16 v[78:79], v3 offset:9216
    ds_read_b32 v162, v160 offset:31744
    buffer_load_dwordx4 v[116:119], v7, s[44:47], s72 offen offset:1024 sc1
    s_waitcnt vmcnt(9)
    v_mfma_f32_32x32x16_bf16 v[8:23], v[88:91], v[124:127], v[8:23]
    ds_read_b64_tr_b16 v[80:81], v2 offset:10240
    ds_read_b64_tr_b16 v[82:83], v2 offset:11264
    v_mfma_f32_32x32x16_bf16 v[24:39], v[92:95], v[124:127], v[24:39]
    ds_read_b64_tr_b16 v[84:85], v3 offset:10240
    ds_read_b64_tr_b16 v[86:87], v3 offset:11264
    s_add_u32 s72, s68, 43008
    buffer_load_dwordx4 v[120:123], v1, s[44:47], s72 offen offset:0 sc1
    s_waitcnt vmcnt(9)
    v_mfma_f32_32x32x16_bf16 v[8:23], v[96:99], v[128:131], v[8:23]
    ds_read_b64_tr_b16 v[88:89], v2 offset:12288
    ds_read_b64_tr_b16 v[90:91], v2 offset:13312
    v_mfma_f32_32x32x16_bf16 v[24:39], v[100:103], v[128:131], v[24:39]
    ds_read_b64_tr_b16 v[92:93], v3 offset:12288
    ds_read_b64_tr_b16 v[94:95], v3 offset:13312
    buffer_load_dwordx4 v[124:127], v1, s[44:47], s72 offen offset:1024 sc1
    s_waitcnt vmcnt(9) lgkmcnt(14)
    v_mfma_f32_32x32x16_bf16 v[8:23], v[40:43], v[132:135], v[8:23]
    ds_read_b64_tr_b16 v[96:97], v2 offset:14336
    ds_read_b64_tr_b16 v[98:99], v2 offset:15360
    v_mfma_f32_32x32x16_bf16 v[24:39], v[44:47], v[132:135], v[24:39]
    ds_read_b64_tr_b16 v[100:101], v3 offset:14336
    ds_read_b64_tr_b16 v[102:103], v3 offset:15360
    buffer_load_dwordx4 v[128:131], v7, s[44:47], s72 offen offset:0 sc1
    s_waitcnt vmcnt(9) lgkmcnt(12)
    v_cmp_gt_u32 vcc, 15, v162
    v_mfma_f32_32x32x16_bf16 v[8:23], v[48:51], v[136:139], v[8:23]
    v_add_u32 v2, 0x00008000, v2
    v_add_u32 v3, 0x00008000, v3
    s_cbranch_vccnz L_g2slow14
L_g2go14:
    ds_read_b64_tr_b16 v[40:41], v2 offset:0
    ds_read_b64_tr_b16 v[42:43], v2 offset:1024
    v_mfma_f32_32x32x16_bf16 v[24:39], v[52:55], v[136:139], v[24:39]
    ds_read_b64_tr_b16 v[44:45], v3 offset:0
    ds_read_b64_tr_b16 v[46:47], v3 offset:1024
    buffer_load_dwordx4 v[132:135], v7, s[44:47], s72 offen offset:1024 sc1
    s_waitcnt vmcnt(9)
    v_mfma_f32_32x32x16_bf16 v[8:23], v[56:59], v[140:143], v[8:23]
    ds_read_b64_tr_b16 v[48:49], v2 offset:2048
    ds_read_b64_tr_b16 v[50:51], v2 offset:3072
    v_mfma_f32_32x32x16_bf16 v[24:39], v[60:63], v[140:143], v[24:39]
    ds_read_b64_tr_b16 v[52:53], v3 offset:2048
    ds_read_b64_tr_b16 v[54:55], v3 offset:3072
    s_add_u32 s72, s68, 51200
    buffer_load_dwordx4 v[136:139], v1, s[44:47], s72 offen offset:0 sc1
    s_waitcnt vmcnt(9)
    v_mfma_f32_32x32x16_bf16 v[8:23], v[64:67], v[144:147], v[8:23]
    ds_read_b64_tr_b16 v[56:57], v2 offset:4096
    ds_read_b64_tr_b16 v[58:59], v2 offset:5120
    v_mfma_f32_32x32x16_bf16 v[24:39], v[68:71], v[144:147], v[24:39]
    ds_read_b64_tr_b16 v[60:61], v3 offset:4096
    ds_read_b64_tr_b16 v[62:63], v3 offset:5120
    buffer_load_dwordx4 v[140:143], v1, s[44:47], s72 offen offset:1024 sc1
    s_waitcnt vmcnt(9)
    v_mfma_f32_32x32x16_bf16 v[8:23], v[72:75], v[104:107], v[8:23]
    ds_read_b64_tr_b16 v[64:65], v2 offset:6144
    ds_read_b64_tr_b16 v[66:67], v2 offset:7168
    v_mfma_f32_32x32x16_bf16 v[24:39], v[76:79], v[104:107], v[24:39]
    ds_read_b64_tr_b16 v[68:69], v3 offset:6144
    ds_read_b64_tr_b16 v[70:71], v3 offset:7168
    buffer_load_dwordx4 v[144:147], v7, s[44:47], s72 offen offset:0 sc1
    s_waitcnt vmcnt(9) lgkmcnt(14)
    v_mfma_f32_32x32x16_bf16 v[8:23], v[80:83], v[108:111], v[8:23]
    ds_read_b64_tr_b16 v[72:73], v2 offset:8192
    ds_read_b64_tr_b16 v[74:75], v2 offset:9216
    v_mfma_f32_32x32x16_bf16 v[24:39], v[84:87], v[108:111], v[24:39]
    ds_read_b64_tr_b16 v[76:77], v3 offset:8192
    ds_read_b64_tr_b16 v[78:79], v3 offset:9216
    buffer_load_dwordx4 v[104:107], v7, s[44:47], s72 offen offset:1024 sc1
    s_waitcnt vmcnt(9)
    v_mfma_f32_32x32x16_bf16 v[8:23], v[88:91], v[112:115], v[8:23]
    ds_read_b64_tr_b16 v[80:81], v2 offset:10240
    ds_read_b64_tr_b16 v[82:83], v2 offset:11264
    v_mfma_f32_32x32x16_bf16 v[24:39], v[92:95], v[112:115], v[24:39]
    ds_read_b64_tr_b16 v[84:85], v3 offset:10240
    ds_read_b64_tr_b16 v[86:87], v3 offset:11264
    s_waitcnt vmcnt(8)
    v_mfma_f32_32x32x16_bf16 v[8:23], v[96:99], v[116:119], v[8:23]
    ds_read_b64_tr_b16 v[88:89], v2 offset:12288
    ds_read_b64_tr_b16 v[90:91], v2 offset:13312
    v_mfma_f32_32x32x16_bf16 v[24:39], v[100:103], v[116:119], v[24:39]
    ds_read_b64_tr_b16 v[92:93], v3 offset:12288
    ds_read_b64_tr_b16 v[94:95], v3 offset:13312
    s_waitcnt vmcnt(7) lgkmcnt(14)
    v_mfma_f32_32x32x16_bf16 v[8:23], v[40:43], v[120:123], v[8:23]
    ds_read_b64_tr_b16 v[96:97], v2 offset:14336
    ds_read_b64_tr_b16 v[98:99], v2 offset:15360
    v_mfma_f32_32x32x16_bf16 v[24:39], v[44:47], v[120:123], v[24:39]
    ds_read_b64_tr_b16 v[100:101], v3 offset:14336
    ds_read_b64_tr_b16 v[102:103], v3 offset:15360
    s_waitcnt vmcnt(6)
    v_mfma_f32_32x32x16_bf16 v[8:23], v[48:51], v[124:127], v[8:23]
    ds_read_b32 v148, v160 offset:31792
    ds_read_b32 v149, v160 offset:31824
    s_lshl_b32 s69, s42, 12
    v_add_u32 v164, s69, v1
    s_xor_b32 s69, s69, 0x2000
    v_add_u32 v165, s69, v1
    v_mfma_f32_32x32x16_bf16 v[24:39], v[52:55], v[124:127], v[24:39]
    s_waitcnt vmcnt(5)
    v_mfma_f32_32x32x16_bf16 v[24:39], v[60:63], v[128:131], v[24:39]
    s_waitcnt vmcnt(4) lgkmcnt(14)
    v_mfma_f32_32x32x16_bf16 v[24:39], v[68:71], v[132:135], v[24:39]
    s_waitcnt vmcnt(3)
    v_mfma_f32_32x32x16_bf16 v[24:39], v[76:79], v[136:139], v[24:39]
    s_waitcnt vmcnt(2) lgkmcnt(10)
    v_mfma_f32_32x32x16_bf16 v[24:39], v[84:87], v[140:143], v[24:39]
    s_waitcnt vmcnt(1) lgkmcnt(6)
    v_mfma_f32_32x32x16_bf16 v[24:39], v[92:95], v[144:147], v[24:39]
    s_waitcnt vmcnt(0) lgkmcnt(2)
    v_mfma_f32_32x32x16_bf16 v[24:39], v[100:103], v[104:107], v[24:39]
    s_waitcnt lgkmcnt(0)
    v_add_u32 v148, 2, v148
    v_min_u32 v148, v148, v149
    v_cmp_gt_u32 vcc, 10, v148
    v_mfma_f32_32x32x16_bf16 v[8:23], v[56:59], v[128:131], v[8:23]
    v_mfma_f32_32x32x16_bf16 v[8:23], v[64:67], v[132:135], v[8:23]
    v_xor_b32 v166, 8, v161
    s_lshl_b32 s69, s66, 3
    v_and_b32 v2, 1, v0
    v_lshl_add_u32 v2, v2, 2, s69
    s_mov_b32 s52, s30
    s_mov_b32 s53, s31
    s_mov_b32 s54, 0x00200000
    s_mov_b32 s55, 0x20000
    s_cbranch_vccz L_fin0
    s_mov_b32 s79, 400000
L_lw36:
    ds_read_b32 v162, v160 offset:31792
    s_waitcnt lgkmcnt(0)
    v_cmp_gt_u32 vcc, 8, v162
    s_sub_u32 s79, s79, 1
    s_cbranch_scc1 L_lwd36
    s_cbranch_vccz L_lwd36
    s_sleep 1
    s_branch L_lw36
L_lwd36:
    s_mov_b32 s79, 400000
L_lw37:
    ds_read_b32 v162, v160 offset:31824
    s_waitcnt lgkmcnt(0)
    v_cmp_gt_u32 vcc, 10, v162
    s_sub_u32 s79, s79, 1
    s_cbranch_scc1 L_lwd37
    s_cbranch_vccz L_lwd37
    s_sleep 1
    s_branch L_lw37
L_lwd37:
L_fin0:
    ds_write_b128 v164, v[24:27] offset:0
    ds_write_b128 v164, v[28:31] offset:1024
    v_mfma_f32_32x32x16_bf16 v[8:23], v[72:75], v[136:139], v[8:23]
    ds_write_b128 v164, v[32:35] offset:2048
    ds_write_b128 v164, v[36:39] offset:3072
    v_mov_b32 v162, 2
    s_mov_b64 exec, 1
    ds_write_b32 v161, v162 offset:31808
    s_mov_b64 exec, -1
    ds_read_b64 v[152:153], v5
    v_xor_b32 v7, 16, v5
    ds_read_b64 v[154:155], v7
    v_xor_b32 v7, 32, v5
    ds_read_b64 v[156:157], v7
    v_xor_b32 v7, 48, v5
    ds_read_b64 v[158:159], v7
    v_mfma_f32_32x32x16_bf16 v[8:23], v[80:83], v[140:143], v[8:23]
    v_mfma_f32_32x32x16_bf16 v[8:23], v[88:91], v[144:147], v[8:23]
    v_mfma_f32_32x32x16_bf16 v[8:23], v[96:99], v[104:107], v[8:23]
    v_mov_b32 v40, 0xbfb8aa3b
    v_mov_b32 v42, 1.0
    s_mov_b32 s79, 400000
L_lw38:
    ds_read_b32 v162, v166 offset:31808
    s_waitcnt lgkmcnt(0)
    v_cmp_gt_u32 vcc, 2, v162
    s_sub_u32 s79, s79, 1
    s_cbranch_scc1 L_lwd38
    s_cbranch_vccnz L_lw38
L_lwd38:
    ds_read_b128 v[64:67], v165 offset:0
    ds_read_b128 v[68:71], v165 offset:1024
    ds_read_b128 v[72:75], v165 offset:2048
    ds_read_b128 v[76:79], v165 offset:3072
    ds_read_b32 v162, v2 offset:31792
    v_lshlrev_b32 v44, 16, v152
    v_and_b32 v45, 0xffff0000, v152
    v_lshlrev_b32 v46, 16, v153
    v_and_b32 v47, 0xffff0000, v153
    v_lshlrev_b32 v48, 16, v154
    v_and_b32 v49, 0xffff0000, v154
    v_lshlrev_b32 v50, 16, v155
    v_and_b32 v51, 0xffff0000, v155
    v_lshlrev_b32 v52, 16, v156
    v_and_b32 v53, 0xffff0000, v156
    v_lshlrev_b32 v54, 16, v157
    v_and_b32 v55, 0xffff0000, v157
    v_lshlrev_b32 v56, 16, v158
    v_and_b32 v57, 0xffff0000, v158
    v_lshlrev_b32 v58, 16, v159
    v_and_b32 v59, 0xffff0000, v159
    s_waitcnt lgkmcnt(0)
    v_cmp_gt_u32 vcc, 9, v162
    v_pk_add_f32 v[8:9], v[8:9], v[64:65]
    v_pk_add_f32 v[10:11], v[10:11], v[66:67]
    v_pk_add_f32 v[12:13], v[12:13], v[68:69]
    v_pk_add_f32 v[14:15], v[14:15], v[70:71]
    v_pk_add_f32 v[16:17], v[16:17], v[72:73]
    v_pk_add_f32 v[18:19], v[18:19], v[74:75]
    v_pk_add_f32 v[20:21], v[20:21], v[76:77]
    v_pk_add_f32 v[22:23], v[22:23], v[78:79]
    s_mov_b64 s[64:65], vcc
    s_cbranch_vccnz L_fin1
    ds_read_b64_tr_b16 v[80:81], v6 offset:0
    ds_read_b64_tr_b16 v[82:83], v6 offset:1024
    ds_read_b64_tr_b16 v[84:85], v6 offset:2048
    ds_read_b64_tr_b16 v[86:87], v6 offset:3072
L_fin1:
    v_pk_mul_f32 v[88:89], v[8:9], v[40:41] op_sel_hi:[1,0]
    v_pk_mul_f32 v[90:91], v[10:11], v[40:41] op_sel_hi:[1,0]
    v_pk_mul_f32 v[92:93], v[12:13], v[40:41] op_sel_hi:[1,0]
    v_pk_mul_f32 v[94:95], v[14:15], v[40:41] op_sel_hi:[1,0]
    v_pk_mul_f32 v[96:97], v[16:17], v[40:41] op_sel_hi:[1,0]
    v_pk_mul_f32 v[98:99], v[18:19], v[40:41] op_sel_hi:[1,0]
    v_pk_mul_f32 v[100:101], v[20:21], v[40:41] op_sel_hi:[1,0]
    v_pk_mul_f32 v[102:103], v[22:23], v[40:41] op_sel_hi:[1,0]
    v_exp_f32 v88, v88
    v_exp_f32 v89, v89
    v_exp_f32 v90, v90
    v_exp_f32 v91, v91
    v_exp_f32 v92, v92
    v_exp_f32 v93, v93
    v_exp_f32 v94, v94
    v_exp_f32 v95, v95
    v_exp_f32 v96, v96
    v_exp_f32 v97, v97
    v_exp_f32 v98, v98
    v_exp_f32 v99, v99
    v_exp_f32 v100, v100
    v_exp_f32 v101, v101
    v_exp_f32 v102, v102
    v_exp_f32 v103, v103
    v_pk_add_f32 v[88:89], v[88:89], v[42:43] op_sel_hi:[1,0]
    v_pk_add_f32 v[90:91], v[90:91], v[42:43] op_sel_hi:[1,0]
    v_pk_add_f32 v[92:93], v[92:93], v[42:43] op_sel_hi:[1,0]
    v_pk_add_f32 v[94:95], v[94:95], v[42:43] op_sel_hi:[1,0]
    v_pk_add_f32 v[96:97], v[96:97], v[42:43] op_sel_hi:[1,0]
    v_pk_add_f32 v[98:99], v[98:99], v[42:43] op_sel_hi:[1,0]
    v_pk_add_f32 v[100:101], v[100:101], v[42:43] op_sel_hi:[1,0]
    v_pk_add_f32 v[102:103], v[102:103], v[42:43] op_sel_hi:[1,0]
    v_rcp_f32 v88, v88
    v_rcp_f32 v89, v89
    v_rcp_f32 v90, v90
    v_rcp_f32 v91, v91
    v_rcp_f32 v92, v92
    v_rcp_f32 v93, v93
    v_rcp_f32 v94, v94
    v_rcp_f32 v95, v95
    v_rcp_f32 v96, v96
    v_rcp_f32 v97, v97
    v_rcp_f32 v98, v98
    v_rcp_f32 v99, v99
    v_rcp_f32 v100, v100
    v_rcp_f32 v101, v101
    v_rcp_f32 v102, v102
    v_rcp_f32 v103, v103
    v_pk_mul_f32 v[88:89], v[88:89], v[8:9]
    v_pk_mul_f32 v[90:91], v[90:91], v[10:11]
    v_pk_mul_f32 v[92:93], v[92:93], v[12:13]
    v_pk_mul_f32 v[94:95], v[94:95], v[14:15]
    v_pk_mul_f32 v[96:97], v[96:97], v[16:17]
    v_pk_mul_f32 v[98:99], v[98:99], v[18:19]
    v_pk_mul_f32 v[100:101], v[100:101], v[20:21]
    v_pk_mul_f32 v[102:103], v[102:103], v[22:23]
    s_cmp_eq_u64 s[64:65], 0
    s_cbranch_scc1 L_fin2
    s_mov_b32 s79, 400000
L_lw39:
    ds_read_b32 v162, v2 offset:31792
    s_waitcnt lgkmcnt(0)
    v_cmp_gt_u32 vcc, 9, v162
    s_sub_u32 s79, s79, 1
    s_cbranch_scc1 L_lwd39
    s_cbranch_vccnz L_lw39
L_lwd39:
    ds_read_b64_tr_b16 v[80:81], v6 offset:0
    ds_read_b64_tr_b16 v[82:83], v6 offset:1024
    ds_read_b64_tr_b16 v[84:85], v6 offset:2048
    ds_read_b64_tr_b16 v[86:87], v6 offset:3072
L_fin2:
    s_waitcnt lgkmcnt(2)
    v_lshlrev_b32 v104, 16, v80
    v_and_b32 v105, 0xffff0000, v80
    v_lshlrev_b32 v106, 16, v81
    v_and_b32 v107, 0xffff0000, v81
    v_lshlrev_b32 v108, 16, v82
    v_and_b32 v109, 0xffff0000, v82
    v_lshlrev_b32 v110, 16, v83
    v_and_b32 v111, 0xffff0000, v83
    v_pk_fma_f32 v[88:89], v[88:89], v[104:105], v[44:45]
    v_pk_fma_f32 v[90:91], v[90:91], v[106:107], v[46:47]
    v_pk_fma_f32 v[92:93], v[92:93], v[108:109], v[48:49]
    v_pk_fma_f32 v[94:95], v[94:95], v[110:111], v[50:51]
    v_cvt_pk_bf16_f32 v24, v88, v89
    v_cvt_pk_bf16_f32 v25, v90, v91
    v_cvt_pk_bf16_f32 v26, v92, v93
    v_cvt_pk_bf16_f32 v27, v94, v95
    s_nop 0
    v_permlane32_swap_b32 v24, v26
    v_permlane32_swap_b32 v25, v27
    buffer_store_dwordx4 v[24:27], v4, s[52:55], s70 offen offset:0
    s_waitcnt lgkmcnt(0)
    v_lshlrev_b32 v112, 16, v84
    v_and_b32 v113, 0xffff0000, v84
    v_lshlrev_b32 v114, 16, v85
    v_and_b32 v115, 0xffff0000, v85
    v_lshlrev_b32 v116, 16, v86
    v_and_b32 v117, 0xffff0000, v86
    v_lshlrev_b32 v118, 16, v87
    v_and_b32 v119, 0xffff0000, v87
    v_pk_fma_f32 v[96:97], v[96:97], v[112:113], v[52:53]
    v_pk_fma_f32 v[98:99], v[98:99], v[114:115], v[54:55]
    v_pk_fma_f32 v[100:101], v[100:101], v[116:117], v[56:57]
    v_pk_fma_f32 v[102:103], v[102:103], v[118:119], v[58:59]
    v_cvt_pk_bf16_f32 v28, v96, v97
    v_cvt_pk_bf16_f32 v29, v98, v99
    v_cvt_pk_bf16_f32 v30, v100, v101
    v_cvt_pk_bf16_f32 v31, v102, v103
    s_nop 0
    v_permlane32_swap_b32 v28, v30
    v_permlane32_swap_b32 v29, v31
    buffer_store_dwordx4 v[28:31], v4, s[52:55], s70 offen offset:32
    s_endpgm
L_bslow:
    s_mov_b32 s79, 100000
    s_mov_b64 exec, 0x3fff
L_aqb:
    s_mov_b32 s62, 16
L_aq1b:
    buffer_load_dword v167, v164, s[44:47], 0 offen offset:64 nt
    s_waitcnt vmcnt(0)
    v_cmp_ne_u32 vcc, s63, v167
    s_sub_u32 s62, s62, 1
    s_cbranch_vccz L_aqdb
    s_sleep 2
    s_cmp_lg_u32 s62, 0
    s_cbranch_scc1 L_aq1b
    buffer_store_dword v166, v165, s[44:47], s74 offen sc1
    s_load_dwordx2 s[8:9], s[60:61], 0 glc
    s_load_dwordx2 s[10:11], s[60:61], 128 glc
    s_load_dwordx2 s[12:13], s[60:61], 256 glc
    s_load_dwordx2 s[14:15], s[60:61], 384 glc
    s_load_dwordx2 s[16:17], s[60:61], 512 glc
    s_load_dwordx2 s[18:19], s[60:61], 640 glc
    s_load_dwordx2 s[20:21], s[60:61], 768 glc
    s_waitcnt lgkmcnt(0)
    s_xor_b32 s8, s8, s63
    s_or_b32 s62, s62, s8
    s_xor_b32 s9, s9, s63
    s_or_b32 s62, s62, s9
    s_xor_b32 s10, s10, s63
    s_or_b32 s62, s62, s10
    s_xor_b32 s11, s11, s63
    s_or_b32 s62, s62, s11
    s_xor_b32 s12, s12, s63
    s_or_b32 s62, s62, s12
    s_xor_b32 s13, s13, s63
    s_or_b32 s62, s62, s13
    s_xor_b32 s14, s14, s63
    s_or_b32 s62, s62, s14
    s_xor_b32 s15, s15, s63
    s_or_b32 s62, s62, s15
    s_xor_b32 s16, s16, s63
    s_or_b32 s62, s62, s16
    s_xor_b32 s17, s17, s63
    s_or_b32 s62, s62, s17
    s_xor_b32 s18, s18, s63
    s_or_b32 s62, s62, s18
    s_xor_b32 s19, s19, s63
    s_or_b32 s62, s62, s19
    s_xor_b32 s20, s20, s63
    s_or_b32 s62, s62, s20
    s_xor_b32 s21, s21, s63
    s_or_b32 s62, s62, s21
    s_cbranch_scc0 L_aqdb
    s_sub_u32 s79, s79, 1
    s_cbranch_scc0 L_aqb
L_aqdb:
    s_mov_b64 exec, -1
    s_branch L_bok
L_g2slow9:
    s_mov_b32 s79, 400000
L_lw40:
    ds_read_b32 v162, v160 offset:31744
    s_waitcnt lgkmcnt(0)
    v_cmp_gt_u32 vcc, 10, v162
    s_sub_u32 s79, s79, 1
    s_cbranch_scc1 L_lwd40
    s_cbranch_vccz L_lwd40
    s_sleep 1
    s_branch L_lw40
L_lwd40:
    s_branch L_g2go9
L_g2slow10:
    s_mov_b32 s79, 400000
L_lw41:
    ds_read_b32 v162, v160 offset:31744
    s_waitcnt lgkmcnt(0)
    v_cmp_gt_u32 vcc, 11, v162
    s_sub_u32 s79, s79, 1
    s_cbranch_scc1 L_lwd41
    s_cbranch_vccz L_lwd41
    s_sleep 1
    s_branch L_lw41
L_lwd41:
    s_branch L_g2go10
L_g2slow11:
    s_mov_b32 s79, 400000
L_lw42:
    ds_read_b32 v162, v160 offset:31744
    s_waitcnt lgkmcnt(0)
    v_cmp_gt_u32 vcc, 12, v162
    s_sub_u32 s79, s79, 1
    s_cbranch_scc1 L_lwd42
    s_cbranch_vccz L_lwd42
    s_sleep 1
    s_branch L_lw42
L_lwd42:
    s_branch L_g2go11
L_g2slow12:
    s_mov_b32 s79, 400000
L_lw43:
    ds_read_b32 v162, v160 offset:31744
    s_waitcnt lgkmcnt(0)
    v_cmp_gt_u32 vcc, 13, v162
    s_sub_u32 s79, s79, 1
    s_cbranch_scc1 L_lwd43
    s_cbranch_vccz L_lwd43
    s_sleep 1
    s_branch L_lw43
L_lwd43:
    s_branch L_g2go12
L_g2slow13:
    s_mov_b32 s79, 400000
L_lw44:
    ds_read_b32 v162, v160 offset:31744
    s_waitcnt lgkmcnt(0)
    v_cmp_gt_u32 vcc, 14, v162
    s_sub_u32 s79, s79, 1
    s_cbranch_scc1 L_lwd44
    s_cbranch_vccz L_lwd44
    s_sleep 1
    s_branch L_lw44
L_lwd44:
    s_branch L_g2go13
L_g2slow14:
    s_mov_b32 s79, 400000
L_lw45:
    ds_read_b32 v162, v160 offset:31744
    s_waitcnt lgkmcnt(0)
    v_cmp_gt_u32 vcc, 15, v162
    s_sub_u32 s79, s79, 1
    s_cbranch_scc1 L_lwd45
    s_cbranch_vccz L_lwd45
    s_sleep 1
    s_branch L_lw45
L_lwd45:
    s_branch L_g2go14
L_end:
    s_endpgm
L_code_end:
.section .rodata,"a"
.p2align 6
.amdhsa_kernel recurrent_scan__ssm_conv_s4d__dense_activation_mish__prompt_kernel
  .amdhsa_next_free_vgpr 168
  .amdhsa_next_free_sgpr 102
  .amdhsa_accum_offset 168
  .amdhsa_group_segment_fixed_size 0
  .amdhsa_kernarg_size 112
  .amdhsa_user_sgpr_count 2
  .amdhsa_user_sgpr_kernarg_segment_ptr 1
  .amdhsa_system_sgpr_workgroup_id_x 1
.end_amdhsa_kernel
```
